```python
import torch

def _softmax(x, axis=-1):
    return torch.softmax(x, dim=axis)

def _gelu(x):
    return torch.nn.functional.gelu(x, approximate='tanh')

def _silu(x):
    return torch.nn.functional.silu(x)

def _sigmoid(x):
    return torch.sigmoid(x)

def _layernorm(x, axis=-1, eps=1e-05):
    m = x.mean(dim=axis, keepdim=True)
    v = x.var(dim=axis, keepdim=True, unbiased=False)
    return (x - m) / torch.sqrt(v + eps)

def _scatter_add(tgt, idx, src, axis=0):
    return tgt.clone().index_add_(axis, idx, src)

def _segment_sum(src, seg, n):
    out = torch.zeros((n,) + src.shape[1:], dtype=src.dtype)
    return out.index_add_(0, seg, src)

def _pad(x, pw):
    flat = tuple((v for pair in reversed(pw) for v in pair))
    return torch.nn.functional.pad(x, flat)
kernel_name = 'adaLN_cond__sliding_block_cached__dense_activation_silu__decode'

def setup_inputs():

    _w = lambda a: (lambda t: t.to(torch.bfloat16) if t.is_floating_point() else t)(torch.as_tensor(a))

    def _A_setup():
        B, Sq, D = (1, 1, 1024)
        Hq, Hkv, Sk, Dh = (32, 4, 65536, 128)
        assert Hq % Hkv == 0, (Hq, Hkv)
        return {'x': _w((lambda *s: torch.randn(*s, dtype=torch.bfloat16) * 0.1)(B, Sq, D)), 'k_cache': _w((lambda *s: torch.randn(*s, dtype=torch.bfloat16) * 0.8)(B, Hkv, Sk, Dh)), 'v_cache': _w((lambda *s: torch.randn(*s, dtype=torch.bfloat16) * 3.2)(B, Hkv, Sk, Dh)), 'wq': _w((lambda *s: torch.randn(*s, dtype=torch.bfloat16) * 0.8)(D, Hq * Dh) * D ** (-0.5)), 'wo': _w((lambda *s: torch.randn(*s, dtype=torch.bfloat16) * 3.2)(Hq * Dh, D) * (Hq * Dh) ** (-0.5))}
    _A_in = _A_setup()

    def _B_setup():
        B, S, D, F = (1, 1, 1024, 3584)
        return {'x': _w((lambda *s: torch.randn(*s, dtype=torch.bfloat16) * 0.1)(B, S, D)), 'w1': _w((lambda *s: torch.randn(*s, dtype=torch.bfloat16) * 3.2)(D, F) * D ** (-0.5)), 'w2': _w((lambda *s: torch.randn(*s, dtype=torch.bfloat16) * 3.2)(F, D) * F ** (-0.5))}
    _B_in = _B_setup()
    return {'A_x': _A_in['x'], 'A_k_cache': _A_in['k_cache'], 'A_v_cache': _A_in['v_cache'], 'A_wq': _A_in['wq'], 'A_wo': _A_in['wo'], 'B_x': _B_in['x'], 'B_w1': _B_in['w1'], 'B_w2': _B_in['w2'], 'c': _w((lambda *s: torch.randn(*s, dtype=torch.bfloat16) * 0.4)(1, 1024) * 8.0), 'w_mod': _w((lambda *s: torch.randn(*s, dtype=torch.bfloat16) * 0.4)(1024, 6 * 1024) * 1024 ** (-0.5) * 8.0)}

def reference(A_x, A_k_cache, A_v_cache, A_wq, A_wo, B_x, B_w1, B_w2, c, w_mod):

    def _A_ref(x, k_cache, v_cache, wq, wo):
        B, Sq, D = x.shape
        Hq, Dh = (32, 128)
        Hkv, Sk = (k_cache.shape[1], k_cache.shape[2])
        W = min(4096, max(256, Sk // 4))
        rep = Hq // Hkv
        q = (lambda x, *d: x.permute(*d))((x @ wq).reshape(B, Sq, Hq, Dh), 0, 2, 1, 3)
        k = (lambda x, n, axis: torch.repeat_interleave(x, n, dim=axis))(k_cache[:, :, Sk - W:, :], rep, axis=1)
        v = (lambda x, n, axis: torch.repeat_interleave(x, n, dim=axis))(v_cache[:, :, Sk - W:, :], rep, axis=1)
        scores = torch.einsum('bhqd,bhkd->bhqk', q, k) * Dh ** (-0.5)
        p = _softmax(scores, axis=-1)
        o = torch.einsum('bhqk,bhkd->bhqd', p, v)
        return (lambda x, *d: x.permute(*d))(o, 0, 2, 1, 3).reshape(B, Sq, Hq * Dh) @ wo

    def _B_ref(x, w1, w2):
        h = torch.einsum('bsd,df->bsf', x, w1)
        h = _silu(h)
        out = torch.einsum('bsf,fd->bsd', h, w2)
        return out
    x = A_x
    mod = (_silu(c) @ w_mod).reshape(c.shape[0], 6, 1, -1)
    sa, ca, ga, sb, cb, gb = (mod[:, 0].clone(), mod[:, 1].clone(), mod[:, 2].clone(), mod[:, 3].clone(), mod[:, 4].clone(), mod[:, 5].clone())
    h = _layernorm(x, axis=-1) * (1 + ca) + sa
    x = x + ga * _A_ref(h, A_k_cache, A_v_cache, A_wq, A_wo)
    h = _layernorm(x, axis=-1) * (1 + cb) + sb
    x = x + gb * _B_ref(h, B_w1, B_w2)
    return x
```

```asm
; @launch grid=(256,1,1) block=(512,1,1) lds=74384
.amdgcn_target "amdgcn-amd-amdhsa--gfx950"
.text
.globl adaLN_cond__sliding_block_cached__dense_activation_silu__decode_kernel
.p2align 8
.type adaLN_cond__sliding_block_cached__dense_activation_silu__decode_kernel,@function
adaLN_cond__sliding_block_cached__dense_activation_silu__decode_kernel:
L_start:
    s_cmp_ge_u32 s2, 256
    s_cbranch_scc1 L_end
    s_load_dwordx16 s[64:79], s[0:1], 0
    s_load_dwordx8 s[80:87], s[0:1], 64
    s_load_dwordx2 s[88:89], s[0:1], 96
    v_lshrrev_b32 v1, 6, v0
    s_nop 0
    v_readfirstlane_b32 s3, v1
    v_and_b32 v0, 63, v0
    v_and_b32 v1, 15, v0
    v_lshrrev_b32 v2, 4, v0
    s_and_b32 s4, s2, 7
    s_lshr_b32 s5, s2, 3
    s_cmp_lt_u32 s5, 16
    s_cbranch_scc1 L_nopf
    s_cmp_ge_u32 s3, 4
    s_cbranch_scc1 L_nopf
    s_getpc_b64 s[94:95]
L_pc:
    s_sub_u32 s94, s94, L_pc-L_start
    s_subb_u32 s95, s95, 0
    s_and_b32 s28, s5, 15
    s_lshl_b32 s28, s28, 2
    s_add_u32 s28, s28, s3
    s_lshl_b32 s28, s28, 8
    v_and_b32 v14, 1, v0
    v_lshlrev_b32 v14, 7, v14
    v_add_u32 v14, s28, v14
    v_min_u32 v14, L_last-L_start, v14
    global_load_dword v128, v14, s[94:95]
L_nopf:
    s_mul_i32 s24, s4, 163840
    s_add_u32 s24, s24, 524288
    s_cmp_lt_u32 s3, 4
    s_cbranch_scc1 L_tile
    s_and_b32 s25, s5, 15
    s_mov_b32 s35, s3
    s_lshl_b32 s34, s5, 3
    s_add_u32 s34, s34, s3
    s_cmp_eq_u32 s34, 254
    s_cselect_b32 s25, 14, s25
    s_cselect_b32 s35, 7, s35
    s_cmp_eq_u32 s34, 247
    s_cselect_b32 s35, 6, s35
    s_lshl_b32 s26, s25, 7
    v_lshlrev_b32 v3, 1, v0
    v_add_u32 v3, s26, v3
    v_mul_u32_u24 v4, 196608, v2
    s_mul_i32 s26, s25, 786432
    s_lshl_b32 s27, s4, 8
    s_add_u32 s26, s26, s27
    s_cmp_lg_u32 s3, 4
    s_cbranch_scc1 L_aux567
    s_setprio 2
    s_lshr_b32 s28, s5, 4
    s_lshl_b32 s28, s28, 7
    v_lshrrev_b32 v5, 3, v1
    v_lshlrev_b32 v5, 11, v5
    v_and_b32 v6, 7, v1
    v_lshl_add_u32 v5, v6, 4, v5
    v_add_u32 v5, v5, v4
    s_add_u32 s29, s26, s28
    v_lshlrev_b32 v7, 5, v0
    v_and_b32 v8, 1, v2
    v_lshlrev_b32 v9, 3, v8
    v_lshl_add_u32 v9, v6, 4, v9
    s_add_u32 s27, s27, s28
    v_add_u32 v9, s27, v9
    s_mov_b32 s33, 12288
    v_mov_b32 v56, -1
    v_mov_b32 v57, -1
    v_mov_b32 v58, -1
    v_mov_b32 v59, -1
    v_lshlrev_b32 v60, 4, v0
    v_lshlrev_b32 v61, 2, v0
    s_lshl_b32 s36, s2, 10
    s_add_u32 s36, s36, 262144
    s_xor_b32 s37, s5, 16
    s_mul_i32 s37, s37, 5120
    s_add_u32 s37, s37, s24
    s_add_u32 s38, s37, 4096
    s_lshl_b32 s39, s4, 13
    s_lshl_b32 s22, s25, 9
    s_add_u32 s39, s39, s22
    s_lshl_b32 s22, s28, 1
    s_add_u32 s39, s39, s22
    s_add_u32 s39, s39, 196608
    s_waitcnt lgkmcnt(0)
    s_mov_b32 s8, s88
    s_mov_b32 s9, s89
    s_mov_b32 s10, 268435456
    s_mov_b32 s11, 0x20000
    buffer_store_dwordx4 v[56:59], v60, s[8:11], s36 offen sc1
    buffer_store_dwordx4 v[56:59], v60, s[8:11], s37 offen offset:0 sc1
    buffer_store_dwordx4 v[56:59], v60, s[8:11], s37 offen offset:1024 sc1
    buffer_store_dwordx4 v[56:59], v60, s[8:11], s37 offen offset:2048 sc1
    buffer_store_dwordx4 v[56:59], v60, s[8:11], s37 offen offset:3072 sc1
    buffer_store_dwordx4 v[56:59], v60, s[8:11], s38 offen sc1
    s_sub_u32 s39, s39, 131072
    buffer_load_dword v62, v61, s[8:11], s39 offen sc1
    global_load_ushort v20, v3, s[80:81]
    s_mov_b32 s12, s82
    s_mov_b32 s13, s83
    s_mov_b32 s14, 12582912
    s_mov_b32 s15, 0x20000
    global_load_dwordx4 v[32:35], v7, s[64:65]
    global_load_dwordx4 v[36:39], v7, s[64:65] offset:16
    global_load_dwordx2 v[40:41], v9, s[64:65]
    buffer_load_dwordx4 v[64:67], v5, s[12:15], s29 offen nt
    s_add_u32 s29, s29, s33
    buffer_load_dwordx4 v[68:71], v5, s[12:15], s29 offen nt
    s_add_u32 s29, s29, s33
    buffer_load_dwordx4 v[72:75], v5, s[12:15], s29 offen nt
    s_add_u32 s29, s29, s33
    buffer_load_dwordx4 v[76:79], v5, s[12:15], s29 offen nt
    s_add_u32 s29, s29, s33
    buffer_load_dwordx4 v[80:83], v5, s[12:15], s29 offen nt
    s_add_u32 s29, s29, s33
    buffer_load_dwordx4 v[84:87], v5, s[12:15], s29 offen nt
    s_add_u32 s29, s29, s33
    buffer_load_dwordx4 v[88:91], v5, s[12:15], s29 offen nt
    s_add_u32 s29, s29, s33
    buffer_load_dwordx4 v[92:95], v5, s[12:15], s29 offen nt
    s_add_u32 s29, s29, s33
    buffer_load_dwordx4 v[96:99], v5, s[12:15], s29 offen nt
    s_add_u32 s29, s29, s33
    buffer_load_dwordx4 v[100:103], v5, s[12:15], s29 offen nt
    s_add_u32 s29, s29, s33
    buffer_load_dwordx4 v[104:107], v5, s[12:15], s29 offen nt
    s_add_u32 s29, s29, s33
    buffer_load_dwordx4 v[108:111], v5, s[12:15], s29 offen nt
    s_add_u32 s29, s29, s33
    buffer_load_dwordx4 v[112:115], v5, s[12:15], s29 offen nt
    s_add_u32 s29, s29, s33
    buffer_load_dwordx4 v[116:119], v5, s[12:15], s29 offen nt
    s_add_u32 s29, s29, s33
    buffer_load_dwordx4 v[120:123], v5, s[12:15], s29 offen nt
    s_add_u32 s29, s29, s33
    buffer_load_dwordx4 v[124:127], v5, s[12:15], s29 offen nt
    s_barrier
    s_load_dword s6, s[88:89], 0
    s_mov_b32 s8, s88
    s_mov_b32 s9, s89
    s_mov_b32 s10, 268435456
    s_mov_b32 s11, 0x20000
    s_lshl_b32 s30, s4, 13
    s_lshl_b32 s31, s25, 9
    s_add_u32 s30, s30, s31
    s_lshl_b32 s31, s28, 1
    s_add_u32 s30, s30, s31
    s_add_u32 s31, s30, 131072
    s_add_u32 s30, s30, 65536
    v_lshlrev_b32 v10, 5, v6
    v_lshl_add_u32 v10, v8, 4, v10
    v_and_b32 v14, 1, v1
    v_lshlrev_b32 v14, 4, v14
    v_mov_b32 v15, 65535
    v_lshlrev_b32 v14, v14, v15
    v_lshrrev_b32 v15, 1, v1
    v_cmp_eq_u32 vcc, 0, v15
    s_nop 1
    v_cndmask_b32 v24, 0, v14, vcc
    v_cmp_eq_u32 vcc, 1, v15
    s_nop 1
    v_cndmask_b32 v25, 0, v14, vcc
    v_cmp_eq_u32 vcc, 2, v15
    s_nop 1
    v_cndmask_b32 v26, 0, v14, vcc
    v_cmp_eq_u32 vcc, 3, v15
    s_nop 1
    v_cndmask_b32 v27, 0, v14, vcc
    s_cmp_eq_u32 s25, 0
    s_cselect_b32 s32, 1.0, 0
    v_mov_b32 v12, s32
    s_waitcnt vmcnt(19)
    s_call_b64 s[96:97], L_silu
    s_waitcnt vmcnt(16)
    v_mov_b32 v44, 0x3f803f80
    v_mov_b32 v42, 0
    v_mov_b32 v43, 0
    v_dot2_f32_bf16 v42, v32, v44, v42
    v_dot2_f32_bf16 v43, v32, v32, v43
    v_dot2_f32_bf16 v42, v33, v44, v42
    v_dot2_f32_bf16 v43, v33, v33, v43
    v_dot2_f32_bf16 v42, v34, v44, v42
    v_dot2_f32_bf16 v43, v34, v34, v43
    v_dot2_f32_bf16 v42, v35, v44, v42
    v_dot2_f32_bf16 v43, v35, v35, v43
    v_dot2_f32_bf16 v42, v36, v44, v42
    v_dot2_f32_bf16 v43, v36, v36, v43
    v_dot2_f32_bf16 v42, v37, v44, v42
    v_dot2_f32_bf16 v43, v37, v37, v43
    v_dot2_f32_bf16 v42, v38, v44, v42
    v_dot2_f32_bf16 v43, v38, v38, v43
    v_dot2_f32_bf16 v42, v39, v44, v42
    v_dot2_f32_bf16 v43, v39, v39, v43
    s_nop 2
    v_add_f32_dpp v42, v42, v42 quad_perm:[1,0,3,2] row_mask:0xf bank_mask:0xf
    v_add_f32_dpp v43, v43, v43 quad_perm:[1,0,3,2] row_mask:0xf bank_mask:0xf
    s_nop 0
    v_add_f32_dpp v42, v42, v42 quad_perm:[2,3,0,1] row_mask:0xf bank_mask:0xf
    v_add_f32_dpp v43, v43, v43 quad_perm:[2,3,0,1] row_mask:0xf bank_mask:0xf
    s_nop 0
    v_add_f32_dpp v42, v42, v42 row_half_mirror row_mask:0xf bank_mask:0xf
    v_add_f32_dpp v43, v43, v43 row_half_mirror row_mask:0xf bank_mask:0xf
    s_nop 0
    v_add_f32_dpp v42, v42, v42 row_mirror row_mask:0xf bank_mask:0xf
    v_add_f32_dpp v43, v43, v43 row_mirror row_mask:0xf bank_mask:0xf
    v_mov_b32 v44, v42
    s_nop 1
    v_permlane16_swap_b32 v42, v44
    v_add_f32 v42, v42, v44
    v_mov_b32 v44, v42
    s_nop 1
    v_permlane32_swap_b32 v42, v44
    v_add_f32 v42, v42, v44
    v_mov_b32 v45, v43
    s_nop 1
    v_permlane16_swap_b32 v43, v45
    v_add_f32 v43, v43, v45
    v_mov_b32 v45, v43
    s_nop 1
    v_permlane32_swap_b32 v43, v45
    v_add_f32 v43, v43, v45
    v_mul_f32 v42, 0x3a800000, v42
    v_mul_f32 v43, 0x3a800000, v43
    v_fma_f32 v43, -v42, v42, v43
    v_max_f32 v43, 0, v43
    v_add_f32 v43, 0x3727c5ac, v43
    v_rsq_f32 v43, v43
    v_lshlrev_b32 v44, 16, v40
    v_and_b32 v45, 0xffff0000, v40
    v_lshlrev_b32 v46, 16, v41
    v_and_b32 v47, 0xffff0000, v41
    v_sub_f32 v44, v44, v42
    v_sub_f32 v45, v45, v42
    v_sub_f32 v46, v46, v42
    v_sub_f32 v47, v47, v42
    v_mul_f32 v44, v44, v43
    v_mul_f32 v45, v45, v43
    v_mul_f32 v46, v46, v43
    v_mul_f32 v47, v47, v43
    s_waitcnt lgkmcnt(0)
    s_mul_i32 s7, s6, 1664525
    s_add_u32 s7, s7, 1013904223
    s_lshr_b32 s6, s7, 2
    s_bfe_u32 s22, s6, 0x1000e
    s_lshl_b32 s22, s22, 31
    s_andn2_b32 s6, s6, 0x4000
    s_or_b32 s6, s6, s22
    v_mov_b32 v54, s6
    v_mov_b32 v55, s6
    v_mov_b32 v57, 74368
    s_waitcnt vmcnt(15)
    v_mfma_f32_16x16x32_bf16 v[48:51], v[128:131], v[64:67], 0
    s_waitcnt vmcnt(14)
    v_mfma_f32_16x16x32_bf16 v[48:51], v[132:135], v[68:71], v[48:51]
    s_waitcnt vmcnt(13)
    v_mfma_f32_16x16x32_bf16 v[48:51], v[136:139], v[72:75], v[48:51]
    s_waitcnt vmcnt(12)
    v_mfma_f32_16x16x32_bf16 v[48:51], v[140:143], v[76:79], v[48:51]
    s_waitcnt vmcnt(11)
    v_mfma_f32_16x16x32_bf16 v[48:51], v[144:147], v[80:83], v[48:51]
    s_waitcnt vmcnt(10)
    v_mfma_f32_16x16x32_bf16 v[48:51], v[148:151], v[84:87], v[48:51]
    s_waitcnt vmcnt(9)
    v_mfma_f32_16x16x32_bf16 v[48:51], v[152:155], v[88:91], v[48:51]
    s_waitcnt vmcnt(8)
    v_mfma_f32_16x16x32_bf16 v[48:51], v[156:159], v[92:95], v[48:51]
    s_waitcnt vmcnt(7)
    v_mfma_f32_16x16x32_bf16 v[48:51], v[160:163], v[96:99], v[48:51]
    s_waitcnt vmcnt(6)
    v_mfma_f32_16x16x32_bf16 v[48:51], v[164:167], v[100:103], v[48:51]
    s_waitcnt vmcnt(5)
    v_mfma_f32_16x16x32_bf16 v[48:51], v[168:171], v[104:107], v[48:51]
    s_waitcnt vmcnt(4)
    v_mfma_f32_16x16x32_bf16 v[48:51], v[172:175], v[108:111], v[48:51]
    s_waitcnt vmcnt(3)
    v_mfma_f32_16x16x32_bf16 v[48:51], v[176:179], v[112:115], v[48:51]
    s_waitcnt vmcnt(2)
    v_mfma_f32_16x16x32_bf16 v[48:51], v[180:183], v[116:119], v[48:51]
    s_waitcnt vmcnt(1)
    v_mfma_f32_16x16x32_bf16 v[48:51], v[184:187], v[120:123], v[48:51]
    s_waitcnt vmcnt(0)
    v_mfma_f32_16x16x32_bf16 v[48:51], v[188:191], v[124:127], v[48:51]
    s_nop 7
    v_add_f32_dpp v58, v48, v12 row_ror:8 row_mask:0xf bank_mask:0xf
    v_add_f32_dpp v59, v49, v12 row_ror:8 row_mask:0xf bank_mask:0xf
    v_add_f32_dpp v60, v50, v12 row_ror:8 row_mask:0xf bank_mask:0xf
    v_add_f32_dpp v61, v51, v12 row_ror:8 row_mask:0xf bank_mask:0xf
    v_fmac_f32 v48, v44, v58
    v_fmac_f32 v49, v45, v59
    v_fmac_f32 v50, v46, v60
    v_fmac_f32 v51, v47, v61
    v_cvt_pk_bf16_f32 v52, v48, v49
    v_cvt_pk_bf16_f32 v53, v50, v51
    s_mov_b64 exec, 0x00ff00ff
    buffer_store_dwordx4 v[52:55], v10, s[8:11], s30 offen
    buffer_store_dwordx4 v[52:55], v10, s[8:11], s31 offen sc1
    s_mov_b64 exec, -1
    s_cmp_lt_u32 s5, 16
    s_cbranch_scc1 L_w4nw
    v_min_u32 v9, 39, v0
    v_lshlrev_b32 v9, 7, v9
    buffer_load_dword v11, v9, s[8:11], s37 offen sc1
L_w4nw:
    s_setprio 0
    s_cmp_ge_u32 s5, 16
    s_cselect_b32 s33, 8, 7
    s_lshl_b32 s33, s33, 4
    s_bitcmp1_b32 s33, s35
    s_cbranch_scc0 L_fin
    s_branch L_modtask
L_aux567:
    s_lshr_b32 s28, s5, 4
    s_lshl_b32 s28, s28, 3
    s_add_u32 s28, s28, s3
    s_cmp_eq_u32 s28, 13
    s_cbranch_scc1 L_aux5
    s_cmp_ge_u32 s5, 16
    s_cselect_b32 s33, 8, 7
    s_lshl_b32 s33, s33, 4
    s_bitcmp1_b32 s33, s35
    s_cbranch_scc0 L_end
    s_waitcnt lgkmcnt(0)
    s_mov_b32 s8, s88
    s_mov_b32 s9, s89
    s_mov_b32 s10, 268435456
    s_mov_b32 s11, 0x20000
    s_cmp_lg_u32 s3, 5
    s_cbranch_scc1 L_nqf
    s_load_dword s6, s[88:89], 0
    s_lshl_b32 s28, s4, 13
    s_lshl_b32 s29, s5, 9
    s_add_u32 s28, s28, s29
    s_lshr_b32 s29, s28, 2
    s_add_u32 s28, s28, 196608
    s_add_u32 s29, s29, 32768
    v_mov_b32 v32, -1
    v_mov_b32 v33, -1
    v_lshlrev_b32 v8, 3, v0
    buffer_store_dwordx2 v[32:33], v8, s[8:11], s28 offen sc1
    global_load_ushort v20, v3, s[80:81]
    s_barrier
    s_waitcnt lgkmcnt(0)
    s_mul_i32 s7, s6, 1664525
    s_add_u32 s7, s7, 1013904223
    s_lshr_b32 s6, s7, 2
    s_bfe_u32 s22, s6, 0x1000e
    s_lshl_b32 s22, s22, 31
    s_andn2_b32 s6, s6, 0x4000
    s_or_b32 s6, s6, s22
    v_mov_b32 v10, s6
    s_waitcnt vmcnt(0)
    s_mov_b64 exec, 1
    buffer_store_dword v10, v8, s[8:11], s29 offen sc1
    s_mov_b64 exec, -1
    s_mov_b32 s12, s82
    s_mov_b32 s13, s83
    s_mov_b32 s14, 12582912
    s_mov_b32 s15, 0x20000
    v_and_b32 v14, 1, v1
    v_lshlrev_b32 v14, 4, v14
    v_mov_b32 v15, 65535
    v_lshlrev_b32 v14, v14, v15
    v_lshrrev_b32 v15, 1, v1
    v_cmp_eq_u32 vcc, 0, v15
    s_nop 1
    v_cndmask_b32 v24, 0, v14, vcc
    v_cmp_eq_u32 vcc, 1, v15
    s_nop 1
    v_cndmask_b32 v25, 0, v14, vcc
    v_cmp_eq_u32 vcc, 2, v15
    s_nop 1
    v_cndmask_b32 v26, 0, v14, vcc
    v_cmp_eq_u32 vcc, 3, v15
    s_nop 1
    v_cndmask_b32 v27, 0, v14, vcc
    s_branch L_modprep3
L_nqf:
    global_load_ushort v20, v3, s[80:81]
    s_barrier
    s_branch L_modprep
L_aux5:
    v_mov_b32 v13, 74368
    v_mov_b32 v12, -1
    ds_write_b32 v13, v12
    s_waitcnt lgkmcnt(0)
    s_barrier
    s_load_dword s6, s[88:89], 0
    s_mov_b32 s8, s88
    s_mov_b32 s9, s89
    s_mov_b32 s10, 268435456
    s_mov_b32 s11, 0x20000
    s_waitcnt lgkmcnt(0)
    s_mul_i32 s7, s6, 1664525
    s_add_u32 s7, s7, 1013904223
    s_lshr_b32 s6, s7, 2
    s_bfe_u32 s22, s6, 0x1000e
    s_lshl_b32 s22, s22, 31
    s_andn2_b32 s6, s6, 0x4000
    s_or_b32 s6, s6, s22
    v_mov_b32 v10, s6
    v_and_b32 v14, 7, v0
    v_lshlrev_b32 v14, 13, v14
    v_bfe_u32 v9, v0, 3, 2
    v_lshl_add_u32 v14, v9, 9, v14
    s_lshr_b32 s30, s4, 1
    s_lshl_b32 s30, s30, 11
    v_add_u32 v14, s30, v14
    v_lshrrev_b32 v14, 2, v14
    s_mov_b32 s30, 32768
    s_mov_b32 s20, 0
hv_1:
    buffer_load_dword v32, v14, s[8:11], s30 offen sc1
w_5:
    s_waitcnt vmcnt(0)
    v_cmp_ne_u32 vcc, v10, v32
    s_cbranch_vccz ok_2
    s_sleep 4
    s_add_u32 s20, s20, 1
    s_cmp_lt_u32 s20, 30000
    s_cbranch_scc1 hv_1
ok_2:
    ds_write_b32 v13, v10
    s_barrier
    s_branch L_end
L_modprep:
    s_mov_b32 s12, s82
    s_mov_b32 s13, s83
    s_mov_b32 s14, 12582912
    s_mov_b32 s15, 0x20000
    v_and_b32 v14, 1, v1
    v_lshlrev_b32 v14, 4, v14
    v_mov_b32 v15, 65535
    v_lshlrev_b32 v14, v14, v15
    v_lshrrev_b32 v15, 1, v1
    v_cmp_eq_u32 vcc, 0, v15
    s_nop 1
    v_cndmask_b32 v24, 0, v14, vcc
    v_cmp_eq_u32 vcc, 1, v15
    s_nop 1
    v_cndmask_b32 v25, 0, v14, vcc
    v_cmp_eq_u32 vcc, 2, v15
    s_nop 1
    v_cndmask_b32 v26, 0, v14, vcc
    v_cmp_eq_u32 vcc, 3, v15
    s_nop 1
    v_cndmask_b32 v27, 0, v14, vcc
    s_waitcnt vmcnt(0)
L_modprep3:
    s_call_b64 s[96:97], L_silu
L_modtask:
    v_lshl_add_u32 v5, v1, 4, v4
    s_sub_u32 s27, s35, 2
    s_lshl_b32 s27, s27, 11
    s_add_u32 s26, s26, s27
    s_sub_u32 s27, s35, 4
    s_lshl_b32 s27, s27, 12
    s_lshl_b32 s28, s25, 8
    s_add_u32 s27, s27, s28
    s_add_u32 s27, s27, s24
    v_and_b32 v8, 1, v2
    v_lshlrev_b32 v8, 3, v8
    v_lshl_add_u32 v8, v1, 4, v8
    s_movk_i32 s32, 128
    s_cmp_ge_u32 s5, 16
    s_cbranch_scc1 L_mtB
    s_barrier
    s_barrier
    s_bitcmp1_b32 s32, s35
    s_cbranch_scc0 L_mtgo
    s_barrier
    s_branch L_mtgo
L_mtB:
    s_bitcmp1_b32 s32, s35
    s_cbranch_scc0 L_mtgo
    s_barrier
    s_barrier
    s_barrier
    s_barrier
    s_barrier
    s_barrier
L_mtgo:
    s_mov_b32 s33, 12288
    buffer_load_dwordx4 v[64:67], v5, s[12:15], s26 offen nt
    s_add_u32 s26, s26, s33
    buffer_load_dwordx4 v[68:71], v5, s[12:15], s26 offen nt
    s_add_u32 s26, s26, s33
    buffer_load_dwordx4 v[72:75], v5, s[12:15], s26 offen nt
    s_add_u32 s26, s26, s33
    buffer_load_dwordx4 v[76:79], v5, s[12:15], s26 offen nt
    s_add_u32 s26, s26, s33
    buffer_load_dwordx4 v[80:83], v5, s[12:15], s26 offen nt
    s_add_u32 s26, s26, s33
    buffer_load_dwordx4 v[84:87], v5, s[12:15], s26 offen nt
    s_add_u32 s26, s26, s33
    buffer_load_dwordx4 v[88:91], v5, s[12:15], s26 offen nt
    s_add_u32 s26, s26, s33
    buffer_load_dwordx4 v[92:95], v5, s[12:15], s26 offen nt
    s_add_u32 s26, s26, s33
    buffer_load_dwordx4 v[96:99], v5, s[12:15], s26 offen nt
    s_add_u32 s26, s26, s33
    buffer_load_dwordx4 v[100:103], v5, s[12:15], s26 offen nt
    s_add_u32 s26, s26, s33
    buffer_load_dwordx4 v[104:107], v5, s[12:15], s26 offen nt
    s_add_u32 s26, s26, s33
    buffer_load_dwordx4 v[108:111], v5, s[12:15], s26 offen nt
    s_add_u32 s26, s26, s33
    buffer_load_dwordx4 v[112:115], v5, s[12:15], s26 offen nt
    s_add_u32 s26, s26, s33
    buffer_load_dwordx4 v[116:119], v5, s[12:15], s26 offen nt
    s_add_u32 s26, s26, s33
    buffer_load_dwordx4 v[120:123], v5, s[12:15], s26 offen nt
    s_add_u32 s26, s26, s33
    buffer_load_dwordx4 v[124:127], v5, s[12:15], s26 offen nt
    s_cmp_ge_u32 s5, 16
    s_cbranch_scc1 L_mtnb2
    s_barrier
L_mtnb2:
    s_waitcnt vmcnt(15)
    v_mfma_f32_16x16x32_bf16 v[48:51], v[128:131], v[64:67], 0
    s_waitcnt vmcnt(14)
    v_mfma_f32_16x16x32_bf16 v[48:51], v[132:135], v[68:71], v[48:51]
    s_waitcnt vmcnt(13)
    v_mfma_f32_16x16x32_bf16 v[48:51], v[136:139], v[72:75], v[48:51]
    s_waitcnt vmcnt(12)
    v_mfma_f32_16x16x32_bf16 v[48:51], v[140:143], v[76:79], v[48:51]
    s_waitcnt vmcnt(11)
    v_mfma_f32_16x16x32_bf16 v[48:51], v[144:147], v[80:83], v[48:51]
    s_waitcnt vmcnt(10)
    v_mfma_f32_16x16x32_bf16 v[48:51], v[148:151], v[84:87], v[48:51]
    s_waitcnt vmcnt(9)
    v_mfma_f32_16x16x32_bf16 v[48:51], v[152:155], v[88:91], v[48:51]
    s_waitcnt vmcnt(8)
    v_mfma_f32_16x16x32_bf16 v[48:51], v[156:159], v[92:95], v[48:51]
    s_waitcnt vmcnt(7)
    v_mfma_f32_16x16x32_bf16 v[48:51], v[160:163], v[96:99], v[48:51]
    s_waitcnt vmcnt(6)
    v_mfma_f32_16x16x32_bf16 v[48:51], v[164:167], v[100:103], v[48:51]
    s_waitcnt vmcnt(5)
    v_mfma_f32_16x16x32_bf16 v[48:51], v[168:171], v[104:107], v[48:51]
    s_waitcnt vmcnt(4)
    v_mfma_f32_16x16x32_bf16 v[48:51], v[172:175], v[108:111], v[48:51]
    s_waitcnt vmcnt(3)
    v_mfma_f32_16x16x32_bf16 v[48:51], v[176:179], v[112:115], v[48:51]
    s_waitcnt vmcnt(2)
    v_mfma_f32_16x16x32_bf16 v[48:51], v[180:183], v[116:119], v[48:51]
    s_waitcnt vmcnt(1)
    v_mfma_f32_16x16x32_bf16 v[48:51], v[184:187], v[120:123], v[48:51]
    s_waitcnt vmcnt(0)
    v_mfma_f32_16x16x32_bf16 v[48:51], v[188:191], v[124:127], v[48:51]
    s_nop 7
    v_cvt_pk_bf16_f32 v52, v48, v49
    v_cvt_pk_bf16_f32 v53, v50, v51
    s_cmp_lt_u32 s5, 16
    s_cbranch_scc1 L_mtpub
    s_bitcmp1_b32 s32, s35
    s_cbranch_scc1 L_mtpub
    s_barrier
L_mtpub:
    s_mov_b32 exec_hi, 0
L_mtp1:
    buffer_store_dwordx2 v[52:53], v8, s[8:11], s27 offen
L_mtp2:
    s_add_u32 s27, s27, 81920
    buffer_store_dwordx2 v[52:53], v8, s[8:11], s27 offen sc1
    s_mov_b64 exec, -1
    s_branch L_fin
L_silu:
    v_lshlrev_b32 v20, 16, v20
    v_mul_f32 v21, 0xbfb8aa3b, v20
    v_exp_f32 v21, v21
    s_nop 0
    v_add_f32 v21, 1.0, v21
    v_rcp_f32 v21, v21
    s_nop 0
    v_mul_f32 v20, v20, v21
    v_cvt_pk_bf16_f32 v20, v20, v20
    s_nop 1
    v_and_b32_dpp v128, v20, v24 row_newbcast:0 row_mask:0xf bank_mask:0xf
    v_and_b32_dpp v129, v20, v25 row_newbcast:0 row_mask:0xf bank_mask:0xf
    v_and_b32_dpp v130, v20, v26 row_newbcast:0 row_mask:0xf bank_mask:0xf
    v_and_b32_dpp v131, v20, v27 row_newbcast:0 row_mask:0xf bank_mask:0xf
    v_and_b32_dpp v132, v20, v24 row_newbcast:1 row_mask:0xf bank_mask:0xf
    v_and_b32_dpp v133, v20, v25 row_newbcast:1 row_mask:0xf bank_mask:0xf
    v_and_b32_dpp v134, v20, v26 row_newbcast:1 row_mask:0xf bank_mask:0xf
    v_and_b32_dpp v135, v20, v27 row_newbcast:1 row_mask:0xf bank_mask:0xf
    v_and_b32_dpp v136, v20, v24 row_newbcast:2 row_mask:0xf bank_mask:0xf
    v_and_b32_dpp v137, v20, v25 row_newbcast:2 row_mask:0xf bank_mask:0xf
    v_and_b32_dpp v138, v20, v26 row_newbcast:2 row_mask:0xf bank_mask:0xf
    v_and_b32_dpp v139, v20, v27 row_newbcast:2 row_mask:0xf bank_mask:0xf
    v_and_b32_dpp v140, v20, v24 row_newbcast:3 row_mask:0xf bank_mask:0xf
    v_and_b32_dpp v141, v20, v25 row_newbcast:3 row_mask:0xf bank_mask:0xf
    v_and_b32_dpp v142, v20, v26 row_newbcast:3 row_mask:0xf bank_mask:0xf
    v_and_b32_dpp v143, v20, v27 row_newbcast:3 row_mask:0xf bank_mask:0xf
    v_and_b32_dpp v144, v20, v24 row_newbcast:4 row_mask:0xf bank_mask:0xf
    v_and_b32_dpp v145, v20, v25 row_newbcast:4 row_mask:0xf bank_mask:0xf
    v_and_b32_dpp v146, v20, v26 row_newbcast:4 row_mask:0xf bank_mask:0xf
    v_and_b32_dpp v147, v20, v27 row_newbcast:4 row_mask:0xf bank_mask:0xf
    v_and_b32_dpp v148, v20, v24 row_newbcast:5 row_mask:0xf bank_mask:0xf
    v_and_b32_dpp v149, v20, v25 row_newbcast:5 row_mask:0xf bank_mask:0xf
    v_and_b32_dpp v150, v20, v26 row_newbcast:5 row_mask:0xf bank_mask:0xf
    v_and_b32_dpp v151, v20, v27 row_newbcast:5 row_mask:0xf bank_mask:0xf
    v_and_b32_dpp v152, v20, v24 row_newbcast:6 row_mask:0xf bank_mask:0xf
    v_and_b32_dpp v153, v20, v25 row_newbcast:6 row_mask:0xf bank_mask:0xf
    v_and_b32_dpp v154, v20, v26 row_newbcast:6 row_mask:0xf bank_mask:0xf
    v_and_b32_dpp v155, v20, v27 row_newbcast:6 row_mask:0xf bank_mask:0xf
    v_and_b32_dpp v156, v20, v24 row_newbcast:7 row_mask:0xf bank_mask:0xf
    v_and_b32_dpp v157, v20, v25 row_newbcast:7 row_mask:0xf bank_mask:0xf
    v_and_b32_dpp v158, v20, v26 row_newbcast:7 row_mask:0xf bank_mask:0xf
    v_and_b32_dpp v159, v20, v27 row_newbcast:7 row_mask:0xf bank_mask:0xf
    v_and_b32_dpp v160, v20, v24 row_newbcast:8 row_mask:0xf bank_mask:0xf
    v_and_b32_dpp v161, v20, v25 row_newbcast:8 row_mask:0xf bank_mask:0xf
    v_and_b32_dpp v162, v20, v26 row_newbcast:8 row_mask:0xf bank_mask:0xf
    v_and_b32_dpp v163, v20, v27 row_newbcast:8 row_mask:0xf bank_mask:0xf
    v_and_b32_dpp v164, v20, v24 row_newbcast:9 row_mask:0xf bank_mask:0xf
    v_and_b32_dpp v165, v20, v25 row_newbcast:9 row_mask:0xf bank_mask:0xf
    v_and_b32_dpp v166, v20, v26 row_newbcast:9 row_mask:0xf bank_mask:0xf
    v_and_b32_dpp v167, v20, v27 row_newbcast:9 row_mask:0xf bank_mask:0xf
    v_and_b32_dpp v168, v20, v24 row_newbcast:10 row_mask:0xf bank_mask:0xf
    v_and_b32_dpp v169, v20, v25 row_newbcast:10 row_mask:0xf bank_mask:0xf
    v_and_b32_dpp v170, v20, v26 row_newbcast:10 row_mask:0xf bank_mask:0xf
    v_and_b32_dpp v171, v20, v27 row_newbcast:10 row_mask:0xf bank_mask:0xf
    v_and_b32_dpp v172, v20, v24 row_newbcast:11 row_mask:0xf bank_mask:0xf
    v_and_b32_dpp v173, v20, v25 row_newbcast:11 row_mask:0xf bank_mask:0xf
    v_and_b32_dpp v174, v20, v26 row_newbcast:11 row_mask:0xf bank_mask:0xf
    v_and_b32_dpp v175, v20, v27 row_newbcast:11 row_mask:0xf bank_mask:0xf
    v_and_b32_dpp v176, v20, v24 row_newbcast:12 row_mask:0xf bank_mask:0xf
    v_and_b32_dpp v177, v20, v25 row_newbcast:12 row_mask:0xf bank_mask:0xf
    v_and_b32_dpp v178, v20, v26 row_newbcast:12 row_mask:0xf bank_mask:0xf
    v_and_b32_dpp v179, v20, v27 row_newbcast:12 row_mask:0xf bank_mask:0xf
    v_and_b32_dpp v180, v20, v24 row_newbcast:13 row_mask:0xf bank_mask:0xf
    v_and_b32_dpp v181, v20, v25 row_newbcast:13 row_mask:0xf bank_mask:0xf
    v_and_b32_dpp v182, v20, v26 row_newbcast:13 row_mask:0xf bank_mask:0xf
    v_and_b32_dpp v183, v20, v27 row_newbcast:13 row_mask:0xf bank_mask:0xf
    v_and_b32_dpp v184, v20, v24 row_newbcast:14 row_mask:0xf bank_mask:0xf
    v_and_b32_dpp v185, v20, v25 row_newbcast:14 row_mask:0xf bank_mask:0xf
    v_and_b32_dpp v186, v20, v26 row_newbcast:14 row_mask:0xf bank_mask:0xf
    v_and_b32_dpp v187, v20, v27 row_newbcast:14 row_mask:0xf bank_mask:0xf
    v_and_b32_dpp v188, v20, v24 row_newbcast:15 row_mask:0xf bank_mask:0xf
    v_and_b32_dpp v189, v20, v25 row_newbcast:15 row_mask:0xf bank_mask:0xf
    v_and_b32_dpp v190, v20, v26 row_newbcast:15 row_mask:0xf bank_mask:0xf
    v_and_b32_dpp v191, v20, v27 row_newbcast:15 row_mask:0xf bank_mask:0xf
    s_nop 1
    s_setpc_b64 s[96:97]
L_dma0:
    s_mov_b32 s94, 4
L_dmah0:
    v_mul_u32_u24 v10, s92, v8
    v_add_u32 v10, v10, v9
    s_mov_b32 m0, s23
    s_lshl_b32 s93, s92, 4
    s_mul_i32 s92, s92, 12
L_dmal0:
    buffer_load_dwordx4 v10, s[12:15], s25 offen nt lds
    s_add_u32 m0, m0, 1024
    s_add_u32 s25, s25, s93
    buffer_load_dwordx4 v10, s[12:15], s25 offen nt lds
    s_add_u32 m0, m0, 1024
    s_sub_u32 s25, s25, s92
    buffer_load_dwordx4 v10, s[12:15], s25 offen nt lds
    s_add_u32 m0, m0, 1024
    s_add_u32 s25, s25, s93
    buffer_load_dwordx4 v10, s[12:15], s25 offen nt lds
    s_add_u32 m0, m0, 1024
    s_add_u32 s25, s25, s92
    s_sub_u32 s94, s94, 1
    s_cmp_lg_u32 s94, 0
    s_cbranch_scc1 L_dmal0
    s_setpc_b64 s[96:97]
L_tr:
    s_waitcnt vmcnt(12)
    ds_read_b64_tr_b16 v[64:65], v4 offset:0
    ds_read_b64_tr_b16 v[80:81], v5 offset:0
    ds_read_b64_tr_b16 v[96:97], v6 offset:0
    ds_read_b64_tr_b16 v[112:113], v7 offset:0
    ds_read_b64_tr_b16 v[66:67], v4 offset:2048
    ds_read_b64_tr_b16 v[82:83], v5 offset:2048
    ds_read_b64_tr_b16 v[98:99], v6 offset:2048
    ds_read_b64_tr_b16 v[114:115], v7 offset:2048
    s_waitcnt vmcnt(8)
    ds_read_b64_tr_b16 v[68:69], v4 offset:4096
    ds_read_b64_tr_b16 v[84:85], v5 offset:4096
    ds_read_b64_tr_b16 v[100:101], v6 offset:4096
    ds_read_b64_tr_b16 v[116:117], v7 offset:4096
    ds_read_b64_tr_b16 v[70:71], v4 offset:6144
    ds_read_b64_tr_b16 v[86:87], v5 offset:6144
    ds_read_b64_tr_b16 v[102:103], v6 offset:6144
    ds_read_b64_tr_b16 v[118:119], v7 offset:6144
    s_waitcnt vmcnt(4)
    ds_read_b64_tr_b16 v[72:73], v4 offset:8192
    ds_read_b64_tr_b16 v[88:89], v5 offset:8192
    ds_read_b64_tr_b16 v[104:105], v6 offset:8192
    ds_read_b64_tr_b16 v[120:121], v7 offset:8192
    ds_read_b64_tr_b16 v[74:75], v4 offset:10240
    ds_read_b64_tr_b16 v[90:91], v5 offset:10240
    ds_read_b64_tr_b16 v[106:107], v6 offset:10240
    ds_read_b64_tr_b16 v[122:123], v7 offset:10240
    s_setpc_b64 s[96:97]
L_setup2:
    v_bfe_u32 v14, v0, 2, 3
    v_lshrrev_b32 v15, 5, v0
    v_lshlrev_b32 v15, 10, v15
    v_lshl_add_u32 v15, v14, 7, v15
    v_and_b32 v16, 3, v0
    v_lshl_add_u32 v15, v16, 3, v15
    v_add_u32 v15, s23, v15
    v_lshrrev_b32 v14, 1, v14
    v_xor_b32 v16, 0, v14
    v_lshl_add_u32 v4, v16, 5, v15
    v_xor_b32 v16, 1, v14
    v_lshl_add_u32 v5, v16, 5, v15
    v_xor_b32 v16, 2, v14
    v_lshl_add_u32 v6, v16, 5, v15
    v_xor_b32 v16, 3, v14
    v_lshl_add_u32 v7, v16, 5, v15
    v_lshlrev_b32 v12, 4, v0
    v_lshlrev_b32 v13, 1, v0
    v_and_b32 v14, 1, v1
    v_lshlrev_b32 v14, 4, v14
    v_mov_b32 v15, 16256
    v_lshlrev_b32 v14, v14, v15
    v_lshrrev_b32 v15, 1, v1
    v_cmp_eq_u32 vcc, 0, v15
    s_nop 1
    v_cndmask_b32 v24, 0, v14, vcc
    v_cmp_eq_u32 vcc, 1, v15
    s_nop 1
    v_cndmask_b32 v25, 0, v14, vcc
    v_cmp_eq_u32 vcc, 2, v15
    s_nop 1
    v_cndmask_b32 v26, 0, v14, vcc
    v_cmp_eq_u32 vcc, 3, v15
    s_nop 1
    v_cndmask_b32 v27, 0, v14, vcc
    s_mul_i32 s30, s3, 272
    s_add_u32 s30, s30, 70016
    v_and_b32 v11, 1, v2
    v_lshlrev_b32 v11, 3, v11
    v_lshl_add_u32 v11, v1, 4, v11
    v_add_u32 v161, s30, v11
    s_setpc_b64 s[96:97]
L_tile:
    v_lshrrev_b32 v3, 3, v0
    v_lshrrev_b32 v8, 2, v3
    v_lshlrev_b32 v8, 3, v8
    v_and_or_b32 v8, v3, 3, v8
    v_and_b32 v14, 6, v3
    v_and_b32 v9, 7, v0
    v_xor_b32 v9, v9, v14
    v_lshlrev_b32 v9, 4, v9
    s_lshl_b32 s23, s3, 14
    s_cmp_ge_u32 s5, 16
    s_cbranch_scc1 L_B
    s_lshl_b32 s25, s4, 20
    s_lshl_b32 s26, s5, 9
    s_add_u32 s25, s25, s26
    s_lshl_b32 s27, s3, 7
    s_add_u32 s25, s25, s27
    s_waitcnt lgkmcnt(0)
    s_load_dword s6, s[88:89], 0
    s_mov_b32 s12, s70
    s_mov_b32 s13, s71
    s_mov_b32 s14, 8388608
    s_mov_b32 s15, 0x20000
    v_lshl_add_u32 v10, v8, 13, v9
    s_mov_b32 m0, s23
    s_mov_b32 s93, 131072
    s_mov_b32 s92, 98304
    s_mov_b32 s94, 4
    s_barrier
L_dmaq:
    buffer_load_dwordx4 v10, s[12:15], s25 offen nt lds
    s_add_u32 m0, m0, 1024
    s_add_u32 s25, s25, s93
    buffer_load_dwordx4 v10, s[12:15], s25 offen nt lds
    s_add_u32 m0, m0, 1024
    s_sub_u32 s25, s25, s92
    buffer_load_dwordx4 v10, s[12:15], s25 offen nt lds
    s_add_u32 m0, m0, 1024
    s_add_u32 s25, s25, s93
    buffer_load_dwordx4 v10, s[12:15], s25 offen nt lds
    s_add_u32 m0, m0, 1024
    s_add_u32 s25, s25, s92
    s_sub_u32 s94, s94, 1
    s_cmp_lg_u32 s94, 0
    s_cbranch_scc1 L_dmaq
    s_mov_b32 s8, s88
    s_mov_b32 s9, s89
    s_mov_b32 s10, 268435456
    s_mov_b32 s11, 0x20000
    s_call_b64 s[96:97], L_setup2
    s_lshl_b32 s28, s4, 13
    s_add_u32 s29, s28, 196608
    s_add_u32 s28, s28, 65536
    s_add_u32 s29, s29, s26
    s_add_u32 s29, s29, s27
    s_lshl_b32 s31, s3, 11
    s_add_u32 s28, s28, s31
    v_and_b32 v14, 1, v1
    v_lshlrev_b32 v14, 4, v14
    v_mov_b32 v15, 0x3f80
    v_lshlrev_b32 v14, v14, v15
    v_and_b32 v15, 1, v2
    v_lshlrev_b32 v15, 1, v15
    v_lshrrev_b32 v16, 1, v1
    v_sub_u32 v16, v16, v15
    v_cmp_eq_u32 vcc, 0, v16
    s_nop 1
    v_cndmask_b32 v28, 0, v14, vcc
    v_cmp_eq_u32 vcc, 1, v16
    s_nop 1
    v_cndmask_b32 v29, 0, v14, vcc
    v_mov_b32 v30, 0
    v_mov_b32 v31, 0
    v_and_b32 v15, 1, v2
    v_lshlrev_b32 v160, 7, v15
    v_lshl_add_u32 v160, v1, 3, v160
    v_add_u32 v160, s30, v160
    v_lshl_add_u32 v164, v2, 4, s30
    v_and_b32 v15, 3, v1
    v_mul_u32_u24 v162, 272, v15
    v_lshl_add_u32 v162, v2, 4, v162
    v_add_u32 v162, 70016, v162
    s_waitcnt lgkmcnt(0)
    s_mul_i32 s7, s6, 1664525
    s_add_u32 s7, s7, 1013904223
    s_lshr_b32 s6, s7, 2
    s_bfe_u32 s22, s6, 0x1000e
    s_lshl_b32 s22, s22, 31
    s_andn2_b32 s6, s6, 0x4000
    s_or_b32 s6, s6, s22
    s_call_b64 s[96:97], L_tr
    s_mov_b32 s20, 0
    buffer_load_dwordx4 v[128:131], v12, s[8:11], s28 offen sc1
    buffer_load_dwordx4 v[132:135], v12, s[8:11], s28 offen offset:1024 sc1
    s_waitcnt vmcnt(2)
    ds_read_b64_tr_b16 v[76:77], v4 offset:12288
    ds_read_b64_tr_b16 v[92:93], v5 offset:12288
    ds_read_b64_tr_b16 v[108:109], v6 offset:12288
    ds_read_b64_tr_b16 v[124:125], v7 offset:12288
    ds_read_b64_tr_b16 v[78:79], v4 offset:14336
    ds_read_b64_tr_b16 v[94:95], v5 offset:14336
    ds_read_b64_tr_b16 v[110:111], v6 offset:14336
    ds_read_b64_tr_b16 v[126:127], v7 offset:14336
    s_branch w_10
hv_6:
    s_and_b32 s21, s20, 63
    s_cmp_eq_u32 s21, 63
    s_cselect_b32 s21, 65536, 0
    s_add_u32 s21, s21, s28
    buffer_load_dwordx4 v[128:131], v12, s[8:11], s21 offen sc1
    buffer_load_dwordx4 v[132:135], v12, s[8:11], s21 offen offset:1024 sc1
w_10:
    s_waitcnt vmcnt(0)
    v_bitop3_b32 v18, v130, v134, s6 bitop3:0x7e
    v_cmp_ne_u32 vcc, 0, v18
    s_cbranch_vccz ok_7
    s_add_u32 s20, s20, 1
    s_cmp_lt_u32 s20, 30000
    s_cbranch_scc1 hv_6
ok_7:
    v_mfma_f32_16x16x32_bf16 v[48:51], v[28:31], v[128:131], 0
    v_mfma_f32_16x16x32_bf16 v[48:51], v[28:31], v[132:135], v[48:51]
    s_nop 7
    v_cvt_pk_bf16_f32 v18, v48, v49
    v_cvt_pk_bf16_f32 v19, v50, v51
    s_mov_b32 exec_hi, 0
    ds_write_b64 v160, v[18:19]
    s_mov_b64 exec, -1
    s_waitcnt lgkmcnt(0)
    s_barrier
    ds_read_b128 v[128:131], v162 offset:0
    ds_read_b128 v[132:135], v162 offset:64
    ds_read_b128 v[136:139], v162 offset:128
    ds_read_b128 v[140:143], v162 offset:192
    s_waitcnt lgkmcnt(3)
    v_mfma_f32_16x16x32_bf16 v[32:35], v[128:131], v[64:67], 0
    v_mfma_f32_16x16x32_bf16 v[36:39], v[128:131], v[80:83], 0
    v_mfma_f32_16x16x32_bf16 v[40:43], v[128:131], v[96:99], 0
    v_mfma_f32_16x16x32_bf16 v[44:47], v[128:131], v[112:115], 0
    s_waitcnt lgkmcnt(2)
    v_mfma_f32_16x16x32_bf16 v[32:35], v[132:135], v[68:71], v[32:35]
    v_mfma_f32_16x16x32_bf16 v[36:39], v[132:135], v[84:87], v[36:39]
    v_mfma_f32_16x16x32_bf16 v[40:43], v[132:135], v[100:103], v[40:43]
    v_mfma_f32_16x16x32_bf16 v[44:47], v[132:135], v[116:119], v[44:47]
    s_waitcnt lgkmcnt(1)
    v_mfma_f32_16x16x32_bf16 v[32:35], v[136:139], v[72:75], v[32:35]
    v_mfma_f32_16x16x32_bf16 v[36:39], v[136:139], v[88:91], v[36:39]
    v_mfma_f32_16x16x32_bf16 v[40:43], v[136:139], v[104:107], v[40:43]
    v_mfma_f32_16x16x32_bf16 v[44:47], v[136:139], v[120:123], v[44:47]
    s_waitcnt lgkmcnt(0)
    v_mfma_f32_16x16x32_bf16 v[32:35], v[140:143], v[76:79], v[32:35]
    v_mfma_f32_16x16x32_bf16 v[36:39], v[140:143], v[92:95], v[36:39]
    v_mfma_f32_16x16x32_bf16 v[40:43], v[140:143], v[108:111], v[40:43]
    v_mfma_f32_16x16x32_bf16 v[44:47], v[140:143], v[124:127], v[44:47]
    s_nop 4
    v_pk_add_f32 v[32:33], v[32:33], v[34:35]
    v_pk_add_f32 v[36:37], v[36:37], v[38:39]
    v_pk_add_f32 v[40:41], v[40:41], v[42:43]
    v_pk_add_f32 v[44:45], v[44:45], v[46:47]
    v_add_f32 v32, v32, v33
    v_add_f32 v36, v36, v37
    v_add_f32 v40, v40, v41
    v_add_f32 v44, v44, v45
    v_permlane16_swap_b32 v32, v36
    s_nop 0
    v_permlane16_swap_b32 v40, v44
    s_nop 1
    v_permlane32_swap_b32 v32, v40
    v_cvt_pk_bf16_f32 v18, v32, v32
    buffer_store_short v18, v13, s[8:11], s29 offen sc1
    s_mov_b32 s12, s72
    s_mov_b32 s13, s73
    s_mov_b32 s14, 8388608
    s_mov_b32 s15, 0x20000
    s_lshr_b32 s26, s3, 1
    s_lshl_b32 s27, s5, 1
    s_add_u32 s26, s26, s27
    s_and_b32 s27, s3, 1
    s_lshl_b32 s27, s27, 7
    s_lshl_b32 s31, s4, 8
    s_add_u32 s31, s31, s27
    s_lshl_b32 s25, s26, 18
    s_add_u32 s25, s25, s31
    s_mov_b32 s33, s25
    s_barrier
    v_mov_b32 v17, 0
    s_add_u32 s28, s24, 17920
    s_barrier
    s_mov_b32 s94, 2
    s_movk_i32 s92, 2048
    s_call_b64 s[96:97], L_dmah0
    buffer_load_dword v22, v17, s[8:11], s28 offen sc1
    s_mov_b32 s94, 2
    s_call_b64 s[96:97], L_dmal0
    v_lshrrev_b32 v16, 3, v1
    v_lshlrev_b32 v16, 8, v16
    v_lshl_add_u32 v16, v2, 4, v16
    v_mov_b32 v17, 0
    s_add_u32 s28, s24, 17920
    s_lshl_b32 s29, s26, 9
    s_add_u32 s29, s29, 262144
    s_lshl_b32 s30, s26, 8
    s_add_u32 s30, s30, 278528
    s_lshl_b32 s32, s26, 8
    s_add_u32 s32, s32, s27
    s_add_u32 s32, s32, s24
    s_add_u32 s34, s32, 20480
    s_add_u32 s35, s32, 102400
    s_waitcnt vmcnt(8)
    ds_read_b64_tr_b16 v[64:65], v4 offset:0
    ds_read_b64_tr_b16 v[80:81], v5 offset:0
    ds_read_b64_tr_b16 v[96:97], v6 offset:0
    ds_read_b64_tr_b16 v[112:113], v7 offset:0
    ds_read_b64_tr_b16 v[66:67], v4 offset:2048
    ds_read_b64_tr_b16 v[82:83], v5 offset:2048
    ds_read_b64_tr_b16 v[98:99], v6 offset:2048
    ds_read_b64_tr_b16 v[114:115], v7 offset:2048
    ds_read_b64_tr_b16 v[68:69], v4 offset:4096
    ds_read_b64_tr_b16 v[84:85], v5 offset:4096
    ds_read_b64_tr_b16 v[100:101], v6 offset:4096
    ds_read_b64_tr_b16 v[116:117], v7 offset:4096
    ds_read_b64_tr_b16 v[70:71], v4 offset:6144
    ds_read_b64_tr_b16 v[86:87], v5 offset:6144
    ds_read_b64_tr_b16 v[102:103], v6 offset:6144
    ds_read_b64_tr_b16 v[118:119], v7 offset:6144
    v_cmp_ne_u32 vcc, s6, v22
    s_cbranch_vccnz L_p4slow
    s_waitcnt vmcnt(4)
    ds_read_b64_tr_b16 v[72:73], v4 offset:8192
    ds_read_b64_tr_b16 v[88:89], v5 offset:8192
    ds_read_b64_tr_b16 v[104:105], v6 offset:8192
    ds_read_b64_tr_b16 v[120:121], v7 offset:8192
    ds_read_b64_tr_b16 v[74:75], v4 offset:10240
    ds_read_b64_tr_b16 v[90:91], v5 offset:10240
    ds_read_b64_tr_b16 v[106:107], v6 offset:10240
    ds_read_b64_tr_b16 v[122:123], v7 offset:10240
    s_mov_b32 s20, 0
    buffer_load_dword v20, v17, s[8:11], s30 offen sc1
    buffer_load_dword v21, v17, s[8:11], s30 offen offset:128 sc1
    buffer_load_dwordx4 v[128:131], v16, s[8:11], s29 offen sc1
    buffer_load_dwordx4 v[132:135], v16, s[8:11], s29 offen offset:64 sc1
    buffer_load_dwordx4 v[136:139], v16, s[8:11], s29 offen offset:128 sc1
    buffer_load_dwordx4 v[140:143], v16, s[8:11], s29 offen offset:192 sc1
    s_waitcnt vmcnt(6)
    ds_read_b64_tr_b16 v[76:77], v4 offset:12288
    ds_read_b64_tr_b16 v[92:93], v5 offset:12288
    ds_read_b64_tr_b16 v[108:109], v6 offset:12288
    ds_read_b64_tr_b16 v[124:125], v7 offset:12288
    ds_read_b64_tr_b16 v[78:79], v4 offset:14336
    ds_read_b64_tr_b16 v[94:95], v5 offset:14336
    ds_read_b64_tr_b16 v[110:111], v6 offset:14336
    ds_read_b64_tr_b16 v[126:127], v7 offset:14336
    s_branch w_15
L_p4slow:
    s_waitcnt vmcnt(0)
    ds_read_b64_tr_b16 v[72:73], v4 offset:8192
    ds_read_b64_tr_b16 v[88:89], v5 offset:8192
    ds_read_b64_tr_b16 v[104:105], v6 offset:8192
    ds_read_b64_tr_b16 v[120:121], v7 offset:8192
    ds_read_b64_tr_b16 v[74:75], v4 offset:10240
    ds_read_b64_tr_b16 v[90:91], v5 offset:10240
    ds_read_b64_tr_b16 v[106:107], v6 offset:10240
    ds_read_b64_tr_b16 v[122:123], v7 offset:10240
    ds_read_b64_tr_b16 v[76:77], v4 offset:12288
    ds_read_b64_tr_b16 v[92:93], v5 offset:12288
    ds_read_b64_tr_b16 v[108:109], v6 offset:12288
    ds_read_b64_tr_b16 v[124:125], v7 offset:12288
    ds_read_b64_tr_b16 v[78:79], v4 offset:14336
    ds_read_b64_tr_b16 v[94:95], v5 offset:14336
    ds_read_b64_tr_b16 v[110:111], v6 offset:14336
    ds_read_b64_tr_b16 v[126:127], v7 offset:14336
    s_mov_b32 s20, 0
hv_16:
    s_and_b32 s21, s20, 63
    s_cmp_eq_u32 s21, 63
    s_cselect_b32 s21, 81920, 0
    s_add_u32 s21, s21, s28
    buffer_load_dword v22, v17, s[8:11], s21 offen sc1
w_20:
    s_waitcnt vmcnt(0)
    v_cmp_ne_u32 vcc, s6, v22
    s_cbranch_vccz ok_17
    s_sleep 1
    s_add_u32 s20, s20, 1
    s_cmp_lt_u32 s20, 30000
    s_cbranch_scc1 hv_16
ok_17:
    s_mov_b32 s20, 0
hv_11:
    buffer_load_dword v20, v17, s[8:11], s30 offen sc1
    buffer_load_dword v21, v17, s[8:11], s30 offen offset:128 sc1
    buffer_load_dwordx4 v[128:131], v16, s[8:11], s29 offen sc1
    buffer_load_dwordx4 v[132:135], v16, s[8:11], s29 offen offset:64 sc1
    buffer_load_dwordx4 v[136:139], v16, s[8:11], s29 offen offset:128 sc1
    buffer_load_dwordx4 v[140:143], v16, s[8:11], s29 offen offset:192 sc1
w_15:
    s_waitcnt vmcnt(0)
    s_waitcnt lgkmcnt(0)
    v_mfma_f32_16x16x32_bf16 v[32:35], v[128:131], v[64:67], 0
    v_max3_u32 v18, v20, v21, v128
    v_max3_u32 v18, v18, v129, v130
    v_mfma_f32_16x16x32_bf16 v[36:39], v[128:131], v[80:83], 0
    v_max3_u32 v18, v18, v131, v132
    v_max3_u32 v18, v18, v133, v134
    v_mfma_f32_16x16x32_bf16 v[40:43], v[128:131], v[96:99], 0
    v_max3_u32 v18, v18, v135, v136
    v_max3_u32 v18, v18, v137, v138
    v_mfma_f32_16x16x32_bf16 v[44:47], v[128:131], v[112:115], 0
    v_max3_u32 v18, v18, v139, v140
    v_max3_u32 v18, v18, v141, v142
    v_max_u32 v18, v18, v143
    v_cmp_eq_u32 vcc, -1, v18
    s_cbranch_vccz ok_12
    s_sleep 1
    s_add_u32 s20, s20, 1
    s_cmp_lt_u32 s20, 30000
    s_cbranch_scc1 hv_11
ok_12:
    v_mfma_f32_16x16x32_bf16 v[32:35], v[132:135], v[68:71], v[32:35]
    v_sub_f32 v21, v21, v20
    v_mfma_f32_16x16x32_bf16 v[36:39], v[132:135], v[84:87], v[36:39]
    v_exp_f32 v21, v21
    v_mfma_f32_16x16x32_bf16 v[40:43], v[132:135], v[100:103], v[40:43]
    v_add_f32 v21, 1.0, v21
    v_mfma_f32_16x16x32_bf16 v[44:47], v[132:135], v[116:119], v[44:47]
    v_rcp_f32 v21, v21
    v_mfma_f32_16x16x32_bf16 v[32:35], v[136:139], v[72:75], v[32:35]
    v_sub_f32 v20, 1.0, v21
    v_mfma_f32_16x16x32_bf16 v[36:39], v[136:139], v[88:91], v[36:39]
    v_mfma_f32_16x16x32_bf16 v[40:43], v[136:139], v[104:107], v[40:43]
    v_mfma_f32_16x16x32_bf16 v[44:47], v[136:139], v[120:123], v[44:47]
    v_mfma_f32_16x16x32_bf16 v[32:35], v[140:143], v[76:79], v[32:35]
    v_mfma_f32_16x16x32_bf16 v[36:39], v[140:143], v[92:95], v[36:39]
    v_mfma_f32_16x16x32_bf16 v[40:43], v[140:143], v[108:111], v[40:43]
    v_mfma_f32_16x16x32_bf16 v[44:47], v[140:143], v[124:127], v[44:47]
    s_nop 5
    v_permlane16_swap_b32 v32, v36
    s_nop 0
    v_permlane16_swap_b32 v40, v44
    s_nop 1
    v_permlane32_swap_b32 v32, v40
    v_mul_f32 v18, v32, v21
    v_fmac_f32 v18, v40, v20
    v_cvt_pk_bf16_f32 v18, v18, v18
    buffer_store_short v18, v13, s[8:11], s34 offen
    s_mov_b32 s12, s78
    s_mov_b32 s13, s79
    s_mov_b32 s14, 7340032
    s_mov_b32 s15, 0x20000
    s_mov_b32 s25, s33
    s_barrier
    buffer_store_short v18, v13, s[8:11], s35 offen sc1
    s_cmp_ge_u32 s5, 14
    s_cbranch_scc1 L_fin
    s_movk_i32 s92, 2048
    s_call_b64 s[96:97], L_dma0
    v_mul_u32_u24 v17, 7168, v2
    v_lshl_add_u32 v17, v1, 4, v17
    v_and_b32 v16, 7, v0
    v_lshlrev_b32 v16, 7, v16
    s_mul_i32 s29, s26, 256
    s_add_u32 s29, s29, 286720
    s_mov_b32 s30, 458752
    s_add_u32 s34, s32, 28672
    s_add_u32 s35, s32, 110592
    s_call_b64 s[96:97], L_tr
    s_mov_b32 s20, 0
    buffer_load_dwordx4 v[128:131], v17, s[8:11], s29 offen sc1
    s_add_u32 s22, s29, 28672
    buffer_load_dwordx4 v[132:135], v17, s[8:11], s22 offen sc1
    s_add_u32 s22, s29, 57344
    buffer_load_dwordx4 v[136:139], v17, s[8:11], s22 offen sc1
    s_add_u32 s22, s29, 86016
    buffer_load_dwordx4 v[140:143], v17, s[8:11], s22 offen sc1
    s_add_u32 s22, s29, 114688
    buffer_load_dwordx4 v[144:147], v17, s[8:11], s22 offen sc1
    s_add_u32 s22, s29, 143360
    buffer_load_dwordx4 v[148:151], v17, s[8:11], s22 offen sc1
    buffer_load_dwordx2 v[20:21], v16, s[8:11], s30 offen sc1
    s_waitcnt vmcnt(7)
    ds_read_b64_tr_b16 v[76:77], v4 offset:12288
    ds_read_b64_tr_b16 v[92:93], v5 offset:12288
    ds_read_b64_tr_b16 v[108:109], v6 offset:12288
    ds_read_b64_tr_b16 v[124:125], v7 offset:12288
    ds_read_b64_tr_b16 v[78:79], v4 offset:14336
    ds_read_b64_tr_b16 v[94:95], v5 offset:14336
    ds_read_b64_tr_b16 v[110:111], v6 offset:14336
    ds_read_b64_tr_b16 v[126:127], v7 offset:14336
    s_branch w_25
hv_21:
    buffer_load_dwordx4 v[128:131], v17, s[8:11], s29 offen sc1
    s_add_u32 s22, s29, 28672
    buffer_load_dwordx4 v[132:135], v17, s[8:11], s22 offen sc1
    s_add_u32 s22, s29, 57344
    buffer_load_dwordx4 v[136:139], v17, s[8:11], s22 offen sc1
    s_add_u32 s22, s29, 86016
    buffer_load_dwordx4 v[140:143], v17, s[8:11], s22 offen sc1
    s_add_u32 s22, s29, 114688
    buffer_load_dwordx4 v[144:147], v17, s[8:11], s22 offen sc1
    s_add_u32 s22, s29, 143360
    buffer_load_dwordx4 v[148:151], v17, s[8:11], s22 offen sc1
    buffer_load_dwordx2 v[20:21], v16, s[8:11], s30 offen sc1
w_25:
    s_waitcnt vmcnt(0)
    v_mfma_f32_16x16x32_bf16 v[32:35], v[24:27], v[128:131], 0
    v_mfma_f32_16x16x32_bf16 v[36:39], v[24:27], v[136:139], 0
    v_mfma_f32_16x16x32_bf16 v[40:43], v[24:27], v[144:147], 0
    v_mfma_f32_16x16x32_bf16 v[32:35], v[24:27], v[132:135], v[32:35]
    v_mfma_f32_16x16x32_bf16 v[36:39], v[24:27], v[140:143], v[36:39]
    v_mfma_f32_16x16x32_bf16 v[40:43], v[24:27], v[148:151], v[40:43]
    v_add_f32_dpp v20, v20, v20 quad_perm:[1,0,3,2] row_mask:0xf bank_mask:0xf
    v_add_f32_dpp v21, v21, v21 quad_perm:[1,0,3,2] row_mask:0xf bank_mask:0xf
    s_nop 0
    v_add_f32_dpp v20, v20, v20 quad_perm:[2,3,0,1] row_mask:0xf bank_mask:0xf
    v_add_f32_dpp v21, v21, v21 quad_perm:[2,3,0,1] row_mask:0xf bank_mask:0xf
    s_nop 0
    v_add_f32_dpp v20, v20, v20 row_half_mirror row_mask:0xf bank_mask:0xf
    v_add_f32_dpp v21, v21, v21 row_half_mirror row_mask:0xf bank_mask:0xf
    v_mul_f32 v20, 0x3a800000, v20
    v_mul_f32 v21, 0x3a800000, v21
    v_fma_f32 v21, -v20, v20, v21
    v_add_f32 v22, 0x3727c5ac, v21
    v_max_f32 v22, 0x3727c5ac, v22
    v_rsq_f32 v22, v22
    v_fma_f32 v32, -v20, v36, v32
    v_fma_f32 v33, -v20, v37, v33
    v_fma_f32 v34, -v20, v38, v34
    v_fma_f32 v35, -v20, v39, v35
    v_fma_f32 v32, v32, v22, v40
    v_fma_f32 v33, v33, v22, v41
    v_fma_f32 v34, v34, v22, v42
    v_fma_f32 v35, v35, v22, v43
    v_cmp_u_f32 vcc, v32, v21
    s_cbranch_vccz ok_22
    s_add_u32 s20, s20, 1
    s_cmp_ge_u32 s20, 30000
    s_cbranch_scc1 ok_22
    s_sleep 2
    v_cmp_ne_u32 vcc, -1, v128
    s_cbranch_vccnz hv_21
lt_23:
    s_sleep 1
lt2_24:
    buffer_load_dwordx4 v[128:131], v17, s[8:11], s29 offen sc1
    s_waitcnt vmcnt(0)
    v_cmp_ne_u32 vcc, -1, v128
    s_cbranch_vccnz hv_21
    s_add_u32 s20, s20, 1
    s_cmp_lt_u32 s20, 30000
    s_cbranch_scc1 lt_23
ok_22:
    v_mul_f32 v36, 0xbfb8aa3b, v32
    v_mul_f32 v37, 0xbfb8aa3b, v33
    v_mul_f32 v38, 0xbfb8aa3b, v34
    v_mul_f32 v39, 0xbfb8aa3b, v35
    v_exp_f32 v36, v36
    v_exp_f32 v37, v37
    v_exp_f32 v38, v38
    v_exp_f32 v39, v39
    v_add_f32 v36, 1.0, v36
    v_add_f32 v37, 1.0, v37
    v_add_f32 v38, 1.0, v38
    v_add_f32 v39, 1.0, v39
    v_rcp_f32 v36, v36
    v_rcp_f32 v37, v37
    v_rcp_f32 v38, v38
    v_rcp_f32 v39, v39
    v_mul_f32 v32, v32, v36
    v_mul_f32 v33, v33, v37
    v_mul_f32 v34, v34, v38
    v_mul_f32 v35, v35, v39
    v_cvt_pk_bf16_f32 v18, v32, v33
    v_cvt_pk_bf16_f32 v19, v34, v35
    s_mov_b32 exec_hi, 0
    ds_write_b64 v161, v[18:19]
    s_mov_b64 exec, -1
    ds_read_b128 v[128:131], v164 offset:0
    ds_read_b128 v[132:135], v164 offset:64
    ds_read_b128 v[136:139], v164 offset:128
    ds_read_b128 v[140:143], v164 offset:192
    s_waitcnt lgkmcnt(3)
    v_mfma_f32_16x16x32_bf16 v[48:51], v[128:131], v[64:67], 0
    v_mfma_f32_16x16x32_bf16 v[52:55], v[128:131], v[80:83], 0
    v_mfma_f32_16x16x32_bf16 v[56:59], v[128:131], v[96:99], 0
    v_mfma_f32_16x16x32_bf16 v[60:63], v[128:131], v[112:115], 0
    s_waitcnt lgkmcnt(2)
    v_mfma_f32_16x16x32_bf16 v[48:51], v[132:135], v[68:71], v[48:51]
    v_mfma_f32_16x16x32_bf16 v[52:55], v[132:135], v[84:87], v[52:55]
    v_mfma_f32_16x16x32_bf16 v[56:59], v[132:135], v[100:103], v[56:59]
    v_mfma_f32_16x16x32_bf16 v[60:63], v[132:135], v[116:119], v[60:63]
    s_waitcnt lgkmcnt(1)
    v_mfma_f32_16x16x32_bf16 v[48:51], v[136:139], v[72:75], v[48:51]
    v_mfma_f32_16x16x32_bf16 v[52:55], v[136:139], v[88:91], v[52:55]
    v_mfma_f32_16x16x32_bf16 v[56:59], v[136:139], v[104:107], v[56:59]
    v_mfma_f32_16x16x32_bf16 v[60:63], v[136:139], v[120:123], v[60:63]
    s_waitcnt lgkmcnt(0)
    v_mfma_f32_16x16x32_bf16 v[48:51], v[140:143], v[76:79], v[48:51]
    v_mfma_f32_16x16x32_bf16 v[52:55], v[140:143], v[92:95], v[52:55]
    v_mfma_f32_16x16x32_bf16 v[56:59], v[140:143], v[108:111], v[56:59]
    v_mfma_f32_16x16x32_bf16 v[60:63], v[140:143], v[124:127], v[60:63]
    s_nop 5
    v_permlane16_swap_b32 v48, v52
    s_nop 0
    v_permlane16_swap_b32 v56, v60
    s_nop 1
    v_permlane32_swap_b32 v48, v56
    v_cvt_pk_bf16_f32 v18, v48, v48
    buffer_store_short v18, v13, s[8:11], s34 offen
    buffer_store_short v18, v13, s[8:11], s35 offen sc1
    s_branch L_fin
L_B:
    s_sub_u32 s5, s5, 16
    s_lshr_b32 s26, s4, 1
    s_and_b32 s27, s4, 1
    s_lshl_b32 s27, s27, 4
    s_add_u32 s27, s27, s5
    s_lshl_b32 s25, s26, 24
    s_lshl_b32 s28, s27, 15
    s_add_u32 s25, s25, s28
    s_lshl_b32 s28, s3, 13
    s_add_u32 s25, s25, s28
    s_add_u32 s25, s25, 15728640
    v_lshl_add_u32 v10, v3, 8, v9
    s_waitcnt lgkmcnt(0)
    s_load_dword s6, s[88:89], 0
    s_lshl_b32 s28, s4, 20
    s_lshl_b32 s29, s5, 9
    s_add_u32 s28, s28, s29
    s_lshl_b32 s29, s3, 7
    s_add_u32 s28, s28, s29
    s_add_u32 s28, s28, 524288
    v_min_u32 v14, 63, v0
    v_lshl_add_u32 v14, v14, 13, s28
    s_mov_b32 s12, s66
    s_mov_b32 s13, s67
    s_mov_b32 s14, 67108864
    s_mov_b32 s15, 0x20000
    s_mov_b32 s16, s68
    s_mov_b32 s17, s69
    s_mov_b32 s18, 67108864
    s_mov_b32 s19, 0x20000
    s_mov_b32 s8, s88
    s_mov_b32 s9, s89
    s_mov_b32 s10, 268435456
    s_mov_b32 s11, 0x20000
    s_barrier
    global_load_dword v131, v14, s[70:71] nt
    s_add_u32 m0, s23, 8192
    s_mov_b32 s28, s25
    buffer_load_dwordx4 v10, s[12:15], s28 offen nt lds
    s_add_u32 m0, m0, 1024
    s_add_u32 s28, s28, 2048
    buffer_load_dwordx4 v10, s[12:15], s28 offen nt lds
    s_add_u32 m0, m0, 1024
    s_add_u32 s28, s28, 2048
    buffer_load_dwordx4 v10, s[12:15], s28 offen nt lds
    s_add_u32 m0, m0, 1024
    s_add_u32 s28, s28, 2048
    buffer_load_dwordx4 v10, s[12:15], s28 offen nt lds
    s_add_u32 m0, m0, 1024
    s_add_u32 s28, s28, 4294961280
    buffer_load_dwordx4 v10, s[12:15], s28 offen nt lds
    s_add_u32 m0, m0, 1024
    s_add_u32 s28, s28, 2048
    buffer_load_dwordx4 v10, s[12:15], s28 offen nt lds
    s_add_u32 m0, m0, 1024
    s_add_u32 s28, s28, 2048
    buffer_load_dwordx4 v10, s[12:15], s28 offen nt lds
    s_add_u32 m0, m0, 1024
    s_add_u32 s28, s28, 2048
    buffer_load_dwordx4 v10, s[12:15], s28 offen nt lds
    s_add_u32 m0, m0, 1024
    s_mov_b32 m0, s23
    s_nop 0
    buffer_load_dwordx4 v10, s[16:19], s25 offen nt lds
    s_add_u32 m0, m0, 1024
    s_add_u32 s25, s25, 2048
    buffer_load_dwordx4 v10, s[16:19], s25 offen nt lds
    s_add_u32 m0, m0, 1024
    s_add_u32 s25, s25, 2048
    buffer_load_dwordx4 v10, s[16:19], s25 offen nt lds
    s_add_u32 m0, m0, 1024
    s_add_u32 s25, s25, 2048
    buffer_load_dwordx4 v10, s[16:19], s25 offen nt lds
    s_add_u32 m0, m0, 1024
    s_add_u32 s25, s25, 4294961280
    buffer_load_dwordx4 v10, s[16:19], s25 offen nt lds
    s_add_u32 m0, m0, 1024
    s_add_u32 s25, s25, 2048
    buffer_load_dwordx4 v10, s[16:19], s25 offen nt lds
    s_add_u32 m0, m0, 1024
    s_add_u32 s25, s25, 2048
    buffer_load_dwordx4 v10, s[16:19], s25 offen nt lds
    s_add_u32 m0, m0, 1024
    s_add_u32 s25, s25, 2048
    buffer_load_dwordx4 v10, s[16:19], s25 offen nt lds
    s_add_u32 m0, m0, 1024
    s_call_b64 s[96:97], L_setup2
    v_and_b32 v16, 6, v1
    v_xor_b32 v16, v16, v2
    v_lshlrev_b32 v166, 7, v1
    v_add_u32 v166, s23, v166
    v_xor_b32 v167, 4, v16
    v_lshl_add_u32 v167, v167, 4, v166
    v_lshl_add_u32 v166, v16, 4, v166
    v_and_b32 v14, 1, v1
    v_lshlrev_b32 v14, 4, v14
    v_mov_b32 v15, 16256
    v_lshlrev_b32 v14, v14, v15
    v_lshrrev_b32 v15, 1, v1
    v_cmp_eq_u32 vcc, 4, v15
    s_nop 1
    v_cndmask_b32 v28, 0, v14, vcc
    v_cmp_eq_u32 vcc, 5, v15
    s_nop 1
    v_cndmask_b32 v29, 0, v14, vcc
    v_cmp_eq_u32 vcc, 6, v15
    s_nop 1
    v_cndmask_b32 v30, 0, v14, vcc
    v_cmp_eq_u32 vcc, 7, v15
    s_nop 1
    v_cndmask_b32 v31, 0, v14, vcc
    v_lshlrev_b32 v17, 13, v2
    v_lshl_add_u32 v17, v1, 4, v17
    s_lshl_b32 s29, s26, 11
    s_lshl_b32 s28, s3, 9
    s_add_u32 s29, s29, s28
    s_add_u32 s29, s29, 196608
    v_lshrrev_b32 v15, 1, v2
    s_lshl_b32 s28, s3, 1
    v_add_u32 v15, s28, v15
    v_mul_u32_u24 v15, 272, v15
    v_add_u32 v15, v15, v11
    v_add_u32 v15, 65536, v15
    v_and_b32 v16, 7, v1
    v_mul_u32_u24 v14, 272, v16
    v_lshl_add_u32 v14, v2, 4, v14
    v_add_u32 v14, 65536, v14
    v_lshl_add_u32 v160, v2, 3, v16
    v_lshlrev_b32 v160, 4, v160
    v_add_u32 v160, 67712, v160
    s_lshl_b32 s28, s3, 9
    v_add_u32 v162, s28, v160
    v_lshlrev_b32 v163, 5, v16
    v_add_u32 v163, 69760, v163
    s_lshl_b32 s28, s3, 3
    v_add_u32 v168, s28, v163
    v_lshlrev_b32 v164, 12, v16
    v_lshrrev_b32 v165, 3, v1
    v_lshl_add_u32 v164, v165, 5, v164
    v_lshl_add_u32 v164, v2, 3, v164
    v_lshlrev_b32 v165, 6, v16
    s_lshl_b32 s30, s5, 8
    s_lshl_b32 s28, s3, 6
    s_add_u32 s30, s30, s28
    s_add_u32 s30, s30, s24
    s_add_u32 s30, s30, 36864
    s_lshl_b32 s31, s5, 2
    s_add_u32 s31, s31, s24
    s_add_u32 s31, s31, 18432
    s_add_u32 s34, s30, 81920
    s_add_u32 s35, s31, 81920
    s_lshr_b32 s28, s3, 1
    s_lshl_b32 s28, s28, 12
    s_sub_u32 s28, s28, s23
    s_bitcmp1_b32 s3, 0
    s_cselect_b64 vcc, -1, 0
    v_cndmask_b32 v169, v4, v6, vcc
    v_cndmask_b32 v170, v5, v7, vcc
    v_add_u32 v169, s28, v169
    v_add_u32 v170, s28, v170
    v_and_b32 v171, 3, v0
    v_lshlrev_b32 v171, 4, v171
    v_bfe_u32 v18, v0, 2, 1
    v_lshl_add_u32 v171, v18, 3, v171
    v_lshrrev_b32 v18, 3, v0
    v_add_lshl_u32 v171, v171, v18, 2
    s_lshl_b32 s28, s3, 1
    s_lshl_b32 s100, 3, s28
    s_mov_b32 s101, 0
    v_mov_b32 v176, 0
    v_mov_b32 v177, 0
    v_mov_b32 v178, 0
    v_mov_b32 v179, 0
    v_mov_b32 v180, 0
    v_mov_b32 v181, 0
    v_mov_b32 v182, 0
    v_mov_b32 v183, 0
    v_mov_b32 v184, 0
    v_mov_b32 v185, 0
    v_mov_b32 v186, 0
    v_mov_b32 v187, 0
    v_mov_b32 v188, 0
    v_mov_b32 v189, 0
    v_mov_b32 v190, 0
    v_mov_b32 v191, 0
    v_mov_b32 v192, 0
    v_mov_b32 v193, 0
    v_mov_b32 v194, 0
    v_mov_b32 v195, 0
    v_mov_b32 v196, 0
    v_mov_b32 v197, 0
    v_mov_b32 v198, 0
    v_mov_b32 v199, 0
    v_mov_b32 v200, 0
    v_mov_b32 v201, 0
    v_mov_b32 v202, 0
    v_mov_b32 v203, 0
    v_mov_b32 v204, 0
    v_mov_b32 v205, 0
    v_mov_b32 v206, 0
    v_mov_b32 v207, 0
    s_mov_b32 s36, 0x00ff00ff
    s_mov_b32 s37, 0x00ff00ff
    s_mov_b32 s38, 0xff00ff00
    s_mov_b32 s39, 0xff00ff00
    v_and_b32 v18, 1, v1
    v_lshlrev_b32 v18, 4, v18
    v_mov_b32 v19, 65535
    v_lshlrev_b32 v18, v18, v19
    v_lshrrev_b32 v19, 1, v1
    v_cmp_eq_u32 vcc, 0, v19
    s_nop 1
    v_cndmask_b32 v172, 0, v18, vcc
    v_cmp_eq_u32 vcc, 1, v19
    s_nop 1
    v_cndmask_b32 v173, 0, v18, vcc
    v_cmp_eq_u32 vcc, 2, v19
    s_nop 1
    v_cndmask_b32 v174, 0, v18, vcc
    v_cmp_eq_u32 vcc, 3, v19
    s_nop 1
    v_cndmask_b32 v175, 0, v18, vcc
    s_mov_b32 s32, 0x3e0293ee
    s_lshl_b32 s33, s5, 2
    s_add_u32 s33, s33, s3
    s_waitcnt lgkmcnt(0)
    s_mul_i32 s7, s6, 1664525
    s_add_u32 s7, s7, 1013904223
    s_lshr_b32 s6, s7, 2
    s_bfe_u32 s22, s6, 0x1000e
    s_lshl_b32 s22, s22, 31
    s_andn2_b32 s6, s6, 0x4000
    s_or_b32 s6, s6, s22
    s_waitcnt vmcnt(8)
    ds_read_b128 v[96:99], v166 offset:8192
    ds_read_b128 v[100:103], v167 offset:8192
    ds_read_b128 v[104:107], v166 offset:12288
    ds_read_b128 v[108:111], v167 offset:12288
    ds_read_b128 v[112:115], v166 offset:10240
    ds_read_b128 v[116:119], v167 offset:10240
    ds_read_b128 v[120:123], v166 offset:14336
    ds_read_b128 v[124:127], v167 offset:14336
    v_mov_b32 v18, 74368
    s_waitcnt vmcnt(3)
    ds_read_b32 v19, v18
    s_waitcnt lgkmcnt(0)
    v_cmp_ne_u32 vcc, s6, v19
    s_cbranch_vccnz L_qlate
    buffer_load_dwordx4 v[128:131], v17, s[8:11], s29 offen sc1
    buffer_load_dwordx4 v[132:135], v17, s[8:11], s29 offen offset:256 sc1
    s_add_u32 s22, s29, 32768
    buffer_load_dwordx4 v[136:139], v17, s[8:11], s22 offen sc1
    buffer_load_dwordx4 v[140:143], v17, s[8:11], s22 offen offset:256 sc1
    s_waitcnt vmcnt(4)
    s_barrier
    s_branch L_qgo
L_qlate:
    s_waitcnt vmcnt(0)
    s_barrier
    buffer_load_dwordx4 v[128:131], v17, s[8:11], s29 offen sc1
    buffer_load_dwordx4 v[132:135], v17, s[8:11], s29 offen offset:256 sc1
    s_add_u32 s22, s29, 32768
    buffer_load_dwordx4 v[136:139], v17, s[8:11], s22 offen sc1
    buffer_load_dwordx4 v[140:143], v17, s[8:11], s22 offen offset:256 sc1
L_qgo:
    s_mov_b32 s20, 0
    ds_read_b64_tr_b16 v[64:65], v169 offset:0
    ds_read_b64_tr_b16 v[66:67], v169 offset:2048
    ds_read_b64_tr_b16 v[68:69], v170 offset:0
    ds_read_b64_tr_b16 v[70:71], v170 offset:2048
    ds_read_b64_tr_b16 v[72:73], v169 offset:16384
    ds_read_b64_tr_b16 v[74:75], v169 offset:18432
    ds_read_b64_tr_b16 v[76:77], v170 offset:16384
    ds_read_b64_tr_b16 v[78:79], v170 offset:18432
    ds_read_b64_tr_b16 v[80:81], v169 offset:32768
    ds_read_b64_tr_b16 v[82:83], v169 offset:34816
    ds_read_b64_tr_b16 v[84:85], v170 offset:32768
    ds_read_b64_tr_b16 v[86:87], v170 offset:34816
    ds_read_b64_tr_b16 v[88:89], v169 offset:49152
    ds_read_b64_tr_b16 v[90:91], v169 offset:51200
    ds_read_b64_tr_b16 v[92:93], v170 offset:49152
    ds_read_b64_tr_b16 v[94:95], v170 offset:51200
    s_branch w_30
hv_26:
    buffer_load_dwordx4 v[128:131], v17, s[8:11], s29 offen sc1
    buffer_load_dwordx4 v[132:135], v17, s[8:11], s29 offen offset:256 sc1
    s_add_u32 s22, s29, 32768
    buffer_load_dwordx4 v[136:139], v17, s[8:11], s22 offen sc1
    buffer_load_dwordx4 v[140:143], v17, s[8:11], s22 offen offset:256 sc1
w_30:
    s_waitcnt vmcnt(0)
    v_mfma_f32_16x16x32_bf16 v[32:35], v[24:27], v[128:131], 0
    v_mfma_f32_16x16x32_bf16 v[32:35], v[28:31], v[132:135], v[32:35]
    v_mfma_f32_16x16x32_bf16 v[32:35], v[24:27], v[136:139], v[32:35]
    v_mfma_f32_16x16x32_bf16 v[32:35], v[28:31], v[140:143], v[32:35]
    s_nop 7
    v_cvt_pk_bf16_f32 v18, v32, v33
    v_cvt_pk_bf16_f32 v19, v34, v35
    v_cmp_u_f32 vcc, v32, v32
    s_cbranch_vccz ok_27
    s_add_u32 s20, s20, 1
    s_cmp_ge_u32 s20, 30000
    s_cbranch_scc1 ok_27
    v_cmp_ne_u32 vcc, -1, v128
    s_cbranch_vccnz hv_26
lt_28:
    s_sleep 1
lt2_29:
    buffer_load_dwordx4 v[128:131], v17, s[8:11], s29 offen sc1
    s_waitcnt vmcnt(0)
    v_cmp_ne_u32 vcc, -1, v128
    s_cbranch_vccnz hv_26
    s_add_u32 s20, s20, 1
    s_cmp_lt_u32 s20, 30000
    s_cbranch_scc1 lt_28
ok_27:
    ds_write_b64 v15, v[18:19]
    s_cmp_lg_u32 s33, 60
    s_cbranch_scc1 L_noaclr
    v_mov_b32 v20, s6
    v_mov_b32 v21, 0
    s_add_u32 s28, s24, 17920
    s_mov_b64 exec, 1
    buffer_store_dword v20, v21, s[8:11], s28 offen
    s_add_u32 s22, s28, 81920
    buffer_store_dword v20, v21, s[8:11], s22 offen sc1
    s_mov_b64 exec, -1
L_noaclr:
    s_waitcnt lgkmcnt(0)
    s_barrier
    ds_read_b128 v[128:131], v14 offset:0
    ds_read_b128 v[132:135], v14 offset:64
    ds_read_b128 v[136:139], v14 offset:128
    ds_read_b128 v[140:143], v14 offset:192
    s_waitcnt lgkmcnt(3)
    v_mfma_f32_16x16x32_bf16 v[32:35], v[96:99], v[128:131], 0
    v_mfma_f32_16x16x32_bf16 v[36:39], v[112:115], v[128:131], 0
    s_waitcnt lgkmcnt(2)
    v_mfma_f32_16x16x32_bf16 v[32:35], v[100:103], v[132:135], v[32:35]
    v_mfma_f32_16x16x32_bf16 v[36:39], v[116:119], v[132:135], v[36:39]
    s_waitcnt lgkmcnt(1)
    v_mfma_f32_16x16x32_bf16 v[32:35], v[104:107], v[136:139], v[32:35]
    v_mfma_f32_16x16x32_bf16 v[36:39], v[120:123], v[136:139], v[36:39]
    s_waitcnt lgkmcnt(0)
    v_mfma_f32_16x16x32_bf16 v[32:35], v[108:111], v[140:143], v[32:35]
    v_mfma_f32_16x16x32_bf16 v[36:39], v[124:127], v[140:143], v[36:39]
    s_nop 6
    v_max3_f32 v18, v32, v33, v34
    v_max3_f32 v19, v36, v37, v38
    v_max3_f32 v18, v18, v35, v39
    v_max_f32 v18, v18, v19
    v_mov_b32 v19, v18
    s_nop 1
    v_permlane16_swap_b32 v18, v19
    v_max_f32 v18, v18, v19
    v_mov_b32 v19, v18
    s_nop 1
    v_permlane32_swap_b32 v18, v19
    v_max_f32 v18, v18, v19
    v_mul_f32 v18, s32, v18
    v_fma_f32 v32, v32, s32, -v18
    v_fma_f32 v33, v33, s32, -v18
    v_fma_f32 v34, v34, s32, -v18
    v_fma_f32 v35, v35, s32, -v18
    v_fma_f32 v36, v36, s32, -v18
    v_fma_f32 v37, v37, s32, -v18
    v_fma_f32 v38, v38, s32, -v18
    v_fma_f32 v39, v39, s32, -v18
    v_exp_f32 v32, v32
    v_exp_f32 v33, v33
    v_exp_f32 v34, v34
    v_exp_f32 v35, v35
    v_exp_f32 v36, v36
    v_exp_f32 v37, v37
    v_exp_f32 v38, v38
    v_exp_f32 v39, v39
    v_cvt_pk_bf16_f32 v20, v32, v33
    v_cvt_pk_bf16_f32 v21, v34, v35
    v_cvt_pk_bf16_f32 v22, v36, v37
    v_cvt_pk_bf16_f32 v23, v38, v39
    ds_write_b128 v162, v[20:23]
    v_pk_add_f32 v[32:33], v[32:33], v[36:37]
    v_pk_add_f32 v[34:35], v[34:35], v[38:39]
    v_pk_add_f32 v[32:33], v[32:33], v[34:35]
    v_add_f32 v19, v32, v33
    v_mov_b32 v32, v19
    s_nop 1
    v_permlane16_swap_b32 v19, v32
    v_add_f32 v19, v19, v32
    v_mov_b32 v32, v19
    s_nop 1
    v_permlane32_swap_b32 v19, v32
    v_add_f32 v19, v19, v32
    ds_write_b64 v168, v[18:19]
    s_waitcnt lgkmcnt(0)
    s_barrier
    ds_read_b128 v[32:35], v163
    ds_read_b128 v[36:39], v163 offset:16
    s_mov_b64 exec, s[36:37]
    ds_read_b128 v[176:179], v160 offset:0
    ds_read_b128 v[184:187], v160 offset:512
    ds_read_b128 v[192:195], v160 offset:1024
    ds_read_b128 v[200:203], v160 offset:1536
    s_mov_b64 exec, s[38:39]
    ds_read_b128 v[180:183], v160 offset:0
    ds_read_b128 v[188:191], v160 offset:512
    ds_read_b128 v[196:199], v160 offset:1024
    ds_read_b128 v[204:207], v160 offset:1536
    s_mov_b64 exec, -1
    s_waitcnt lgkmcnt(8)
    v_max3_f32 v18, v32, v34, v36
    v_max_f32 v18, v18, v38
    s_waitcnt lgkmcnt(7)
    v_mfma_f32_16x16x32_bf16 v[128:131], v[64:67], v[176:179], 0
    v_sub_f32 v32, v32, v18
    v_sub_f32 v34, v34, v18
    s_waitcnt lgkmcnt(6)
    v_mfma_f32_16x16x32_bf16 v[132:135], v[72:75], v[184:187], 0
    v_sub_f32 v36, v36, v18
    v_sub_f32 v38, v38, v18
    s_waitcnt lgkmcnt(5)
    v_mfma_f32_16x16x32_bf16 v[136:139], v[80:83], v[192:195], 0
    v_exp_f32 v32, v32
    v_exp_f32 v34, v34
    s_waitcnt lgkmcnt(4)
    v_mfma_f32_16x16x32_bf16 v[140:143], v[88:91], v[200:203], 0
    v_exp_f32 v36, v36
    v_exp_f32 v38, v38
    s_waitcnt lgkmcnt(3)
    v_mfma_f32_16x16x32_bf16 v[128:131], v[68:71], v[180:183], v[128:131]
    v_mul_f32 v19, v32, v33
    v_fmac_f32 v19, v34, v35
    s_waitcnt lgkmcnt(2)
    v_mfma_f32_16x16x32_bf16 v[132:135], v[76:79], v[188:191], v[132:135]
    v_fmac_f32 v19, v36, v37
    v_fmac_f32 v19, v38, v39
    s_waitcnt lgkmcnt(1)
    v_mfma_f32_16x16x32_bf16 v[136:139], v[84:87], v[196:199], v[136:139]
    v_rcp_f32 v20, v19
    v_log_f32 v21, v19
    s_waitcnt lgkmcnt(0)
    v_mfma_f32_16x16x32_bf16 v[140:143], v[92:95], v[204:207], v[140:143]
    v_mul_f32 v32, v32, v20
    v_mul_f32 v34, v34, v20
    v_mul_f32 v36, v36, v20
    v_mul_f32 v38, v38, v20
    v_add_f32 v21, v21, v18
    v_mul_f32 v128, v128, v32
    v_mul_f32 v129, v129, v32
    v_mul_f32 v130, v130, v32
    v_mul_f32 v131, v131, v32
    v_fmac_f32 v128, v132, v34
    v_fmac_f32 v129, v133, v34
    v_fmac_f32 v130, v134, v34
    v_fmac_f32 v131, v135, v34
    v_fmac_f32 v128, v136, v36
    v_fmac_f32 v129, v137, v36
    v_fmac_f32 v130, v138, v36
    v_fmac_f32 v131, v139, v36
    v_fmac_f32 v128, v140, v38
    v_fmac_f32 v129, v141, v38
    v_fmac_f32 v130, v142, v38
    v_fmac_f32 v131, v143, v38
    v_cvt_pk_bf16_f32 v22, v128, v129
    v_cvt_pk_bf16_f32 v23, v130, v131
    ds_bpermute_b32 v166, v171, v22
    ds_bpermute_b32 v167, v171, v23
    s_mov_b64 exec, s[100:101]
    buffer_store_dword v21, v165, s[8:11], s31 offen
    s_mov_b64 exec, -1
    v_mov_b32 v168, v21
    v_lshrrev_b32 v164, 3, v0
    v_lshlrev_b32 v164, 12, v164
    v_and_b32 v169, 7, v0
    v_lshl_add_u32 v164, v169, 3, v164
    s_waitcnt lgkmcnt(0)
    buffer_store_dwordx2 v[166:167], v164, s[8:11], s30 offen
    s_mov_b32 s12, s76
    s_mov_b32 s13, s77
    s_mov_b32 s14, 7340032
    s_mov_b32 s15, 0x20000
    s_mul_i32 s25, s4, 917504
    s_lshl_b32 s26, s5, 9
    s_lshl_b32 s27, s3, 7
    s_add_u32 s26, s26, s27
    s_add_u32 s25, s25, s26
    s_cmp_ge_u32 s5, 14
    s_waitcnt lgkmcnt(0)
    s_cbranch_scc1 L_F
    s_barrier
    buffer_store_dwordx2 v[166:167], v164, s[8:11], s34 offen sc1
    s_mov_b64 exec, s[100:101]
    buffer_store_dword v168, v165, s[8:11], s35 offen sc1
    s_mov_b64 exec, -1
    s_movk_i32 s92, 7168
    s_call_b64 s[96:97], L_dma0
    v_lshlrev_b32 v16, 1, v11
    v_mov_b32 v15, 5
    v_cmp_gt_u32 vcc, 5, v1
    s_nop 1
    v_cndmask_b32 v15, v15, v1, vcc
    v_lshrrev_b32 v14, 2, v1
    v_cmp_eq_u32 vcc, 2, v14
    s_nop 1
    v_cndmask_b32 v15, v15, v1, vcc
    v_mul_u32_u24 v162, 272, v15
    v_lshl_add_u32 v162, v2, 4, v162
    v_add_u32 v162, 70016, v162
    v_lshlrev_b32 v164, 2, v0
    v_add_u32 v163, 71104, v164
    v_mov_b32 v14, 0
    ds_write_b32 v163, v14 offset:272
    v_lshrrev_b32 v15, 5, v0
    v_mul_u32_u24 v15, 2176, v15
    v_add_u32 v161, v161, v15
    s_add_u32 s28, s24, 16384
    s_lshl_b32 s29, s3, 11
    s_add_u32 s29, s29, s24
    s_add_u32 s29, s29, 20480
    s_add_u32 s34, s24, 4096
    s_lshl_b32 s22, s3, 10
    s_add_u32 s34, s34, s22
    s_mul_i32 s30, s4, 7168
    s_add_u32 s30, s30, s26
    s_add_u32 s30, s30, 286720
    s_add_u32 s31, s30, 57344
    s_add_u32 s32, s30, 114688
    s_cmp_eq_u32 s3, 0
    s_cselect_b32 s33, 1.0, 0
    s_call_b64 s[96:97], L_tr
    s_mov_b32 s20, 0
    buffer_load_dwordx4 v[52:55], v16, s[8:11], s28 offen sc1
    buffer_load_dwordx4 v[56:59], v16, s[8:11], s28 offen offset:512 sc1
    buffer_load_dword v22, v164, s[8:11], s28 offen offset:1024 sc1
    buffer_load_dwordx4 v[136:139], v12, s[8:11], s34 offen sc1
    buffer_load_dwordx4 v[128:131], v12, s[8:11], s29 offen sc1
    buffer_load_dwordx4 v[132:135], v12, s[8:11], s29 offen offset:1024 sc1
    s_waitcnt vmcnt(6)
    ds_read_b64_tr_b16 v[76:77], v4 offset:12288
    ds_read_b64_tr_b16 v[92:93], v5 offset:12288
    ds_read_b64_tr_b16 v[108:109], v6 offset:12288
    ds_read_b64_tr_b16 v[124:125], v7 offset:12288
    ds_read_b64_tr_b16 v[78:79], v4 offset:14336
    ds_read_b64_tr_b16 v[94:95], v5 offset:14336
    ds_read_b64_tr_b16 v[110:111], v6 offset:14336
    ds_read_b64_tr_b16 v[126:127], v7 offset:14336
    s_branch w_35
hv_31:
    s_and_b32 s21, s20, 63
    s_cmp_eq_u32 s21, 63
    s_cselect_b32 s21, 81920, 0
    s_add_u32 s21, s21, s28
    buffer_load_dwordx4 v[52:55], v16, s[8:11], s21 offen sc1
    buffer_load_dwordx4 v[56:59], v16, s[8:11], s21 offen offset:512 sc1
    buffer_load_dword v22, v164, s[8:11], s21 offen offset:1024 sc1
    s_sub_u32 s38, s21, s28
    s_add_u32 s38, s38, s34
    buffer_load_dwordx4 v[136:139], v12, s[8:11], s38 offen sc1
    s_sub_u32 s38, s21, s28
    s_add_u32 s38, s38, s29
    buffer_load_dwordx4 v[128:131], v12, s[8:11], s38 offen sc1
    buffer_load_dwordx4 v[132:135], v12, s[8:11], s38 offen offset:1024 sc1
w_35:
    s_waitcnt vmcnt(0)
    v_max3_u32 v18, v52, v53, v54
    v_max3_u32 v18, v18, v55, v56
    v_max3_u32 v18, v18, v57, v58
    v_max3_u32 v18, v18, v59, v22
    v_max3_u32 v18, v18, v136, v137
    v_max3_u32 v18, v18, v138, v139
    v_cmp_eq_u32 vcc, -1, v18
    s_cbranch_vccz ok_32
    s_sleep 1
    s_add_u32 s20, s20, 1
    s_cmp_lt_u32 s20, 30000
    s_cbranch_scc1 hv_31
ok_32:
    s_mov_b32 s20, 0
    ds_write_b32 v163, v22
    v_mul_f32 v56, s33, v56
    v_mul_f32 v57, s33, v57
    v_mul_f32 v58, s33, v58
    v_mul_f32 v59, s33, v59
    s_mov_b32 exec_lo, 0
    v_mov_b32 v52, 1.0
    v_mov_b32 v56, 0
    v_mov_b32 v53, 1.0
    v_mov_b32 v57, 0
    v_mov_b32 v54, 1.0
    v_mov_b32 v58, 0
    v_mov_b32 v55, 1.0
    v_mov_b32 v59, 0
    s_mov_b64 exec, -1
    v_mfma_f32_16x16x32_bf16 v[60:63], v[28:31], v[136:139], 0
    s_nop 5
    s_branch w_40
hv_36:
    s_and_b32 s21, s20, 63
    s_cmp_eq_u32 s21, 63
    s_cselect_b32 s21, 81920, 0
    s_add_u32 s21, s21, s29
    buffer_load_dwordx4 v[128:131], v12, s[8:11], s21 offen sc1
    buffer_load_dwordx4 v[132:135], v12, s[8:11], s21 offen offset:1024 sc1
w_40:
    s_waitcnt vmcnt(0)
    v_mfma_f32_16x16x32_bf16 v[48:51], v[24:27], v[128:131], v[60:63]
    v_mfma_f32_16x16x32_bf16 v[48:51], v[24:27], v[132:135], v[48:51]
    s_nop 7
    v_fma_f32 v48, v48, v52, v56
    v_fma_f32 v49, v49, v53, v57
    v_fma_f32 v50, v50, v54, v58
    v_fma_f32 v51, v51, v55, v59
    v_cvt_pk_bf16_f32 v18, v48, v49
    v_cvt_pk_bf16_f32 v19, v50, v51
    v_cmp_u_f32 vcc, v48, v48
    s_cbranch_vccz ok_37
    s_add_u32 s20, s20, 1
    s_cmp_ge_u32 s20, 30000
    s_cbranch_scc1 ok_37
    v_cmp_ne_u32 vcc, -1, v128
    s_cbranch_vccnz hv_36
lt_38:
    s_sleep 1
lt2_39:
    s_and_b32 s21, s20, 63
    s_cmp_eq_u32 s21, 63
    s_cselect_b32 s21, 81920, 0
    s_add_u32 s21, s21, s29
    buffer_load_dwordx4 v[128:131], v12, s[8:11], s21 offen sc1
    s_waitcnt vmcnt(0)
    v_cmp_ne_u32 vcc, -1, v128
    s_cbranch_vccnz hv_36
    s_add_u32 s20, s20, 1
    s_cmp_lt_u32 s20, 30000
    s_cbranch_scc1 lt_38
ok_37:
    ds_write_b64 v161, v[18:19]
    s_waitcnt lgkmcnt(0)
    s_barrier
    ds_read_b128 v[128:131], v162 offset:0
    ds_read_b128 v[132:135], v162 offset:64
    ds_read_b128 v[136:139], v162 offset:128
    ds_read_b128 v[140:143], v162 offset:192
    s_waitcnt lgkmcnt(3)
    v_mfma_f32_16x16x32_bf16 v[32:35], v[128:131], v[64:67], 0
    v_mfma_f32_16x16x32_bf16 v[36:39], v[128:131], v[80:83], 0
    v_mfma_f32_16x16x32_bf16 v[40:43], v[128:131], v[96:99], 0
    v_mfma_f32_16x16x32_bf16 v[44:47], v[128:131], v[112:115], 0
    s_waitcnt lgkmcnt(2)
    v_mfma_f32_16x16x32_bf16 v[32:35], v[132:135], v[68:71], v[32:35]
    v_mfma_f32_16x16x32_bf16 v[36:39], v[132:135], v[84:87], v[36:39]
    v_mfma_f32_16x16x32_bf16 v[40:43], v[132:135], v[100:103], v[40:43]
    v_mfma_f32_16x16x32_bf16 v[44:47], v[132:135], v[116:119], v[44:47]
    s_waitcnt lgkmcnt(1)
    v_mfma_f32_16x16x32_bf16 v[32:35], v[136:139], v[72:75], v[32:35]
    v_mfma_f32_16x16x32_bf16 v[36:39], v[136:139], v[88:91], v[36:39]
    v_mfma_f32_16x16x32_bf16 v[40:43], v[136:139], v[104:107], v[40:43]
    v_mfma_f32_16x16x32_bf16 v[44:47], v[136:139], v[120:123], v[44:47]
    s_waitcnt lgkmcnt(0)
    v_mfma_f32_16x16x32_bf16 v[32:35], v[140:143], v[76:79], v[32:35]
    v_mfma_f32_16x16x32_bf16 v[36:39], v[140:143], v[92:95], v[36:39]
    v_mfma_f32_16x16x32_bf16 v[40:43], v[140:143], v[108:111], v[40:43]
    v_mfma_f32_16x16x32_bf16 v[44:47], v[140:143], v[124:127], v[44:47]
    s_nop 4
    v_pk_add_f32 v[32:33], v[32:33], v[34:35]
    v_pk_add_f32 v[36:37], v[36:37], v[38:39]
    v_pk_add_f32 v[40:41], v[40:41], v[42:43]
    v_pk_add_f32 v[44:45], v[44:45], v[46:47]
    v_add_f32 v32, v32, v33
    v_add_f32 v36, v36, v37
    v_add_f32 v40, v40, v41
    v_add_f32 v44, v44, v45
    v_permlane16_swap_b32 v32, v36
    s_nop 0
    v_permlane16_swap_b32 v40, v44
    s_nop 1
    v_permlane32_swap_b32 v32, v40
    v_permlane32_swap_b32 v36, v44
    v_cvt_pk_bf16_f32 v18, v32, v40
    v_cvt_pk_bf16_f32 v19, v36, v36
    buffer_store_short v18, v13, s[8:11], s30 offen sc1
    buffer_store_short_d16_hi v18, v13, s[8:11], s32 offen sc1
    buffer_store_short v19, v13, s[8:11], s31 offen sc1
    s_branch L_fin
L_F:
    s_sub_u32 s26, s33, 56
    s_lshl_b32 s28, s26, 6
    s_add_u32 s28, s28, s24
    s_add_u32 s28, s28, 18432
    s_lshl_b32 s29, s26, 12
    s_add_u32 s29, s29, s24
    s_add_u32 s29, s29, 36864
    v_and_b32 v15, 3, v1
    v_lshl_add_u32 v15, v15, 2, v2
    v_lshlrev_b32 v15, 2, v15
    s_lshr_b32 s30, s4, 1
    s_lshl_b32 s30, s30, 3
    s_add_u32 s30, s30, s26
    s_lshl_b32 s30, s30, 1
    s_and_b32 s31, s4, 1
    s_add_u32 s30, s30, s31
    s_lshl_b32 s31, s30, 7
    s_add_u32 s31, s31, 278528
    s_lshl_b32 s30, s30, 8
    s_add_u32 s30, s30, 262144
    v_mov_b32 v23, 0
    s_mov_b32 s20, 0
hv_41:
    s_and_b32 s21, s20, 63
    s_cmp_eq_u32 s21, 63
    s_cselect_b32 s21, 81920, 0
    s_add_u32 s21, s21, s28
    buffer_load_dword v21, v15, s[8:11], s21 offen sc1
    s_sub_u32 s38, s21, s28
    s_add_u32 s38, s38, s29
    buffer_load_dwordx4 v[128:131], v12, s[8:11], s38 offen sc1
    buffer_load_dwordx4 v[132:135], v12, s[8:11], s38 offen offset:1024 sc1
    buffer_load_dwordx4 v[136:139], v12, s[8:11], s38 offen offset:2048 sc1
    buffer_load_dwordx4 v[140:143], v12, s[8:11], s38 offen offset:3072 sc1
w_45:
    s_waitcnt vmcnt(0)
    v_max_f32_dpp v18, v21, v21 quad_perm:[1,0,3,2] row_mask:0xf bank_mask:0xf
    v_max3_u32 v20, v21, v128, v129
    v_max3_u32 v20, v20, v130, v131
    v_max_f32_dpp v18, v18, v18 quad_perm:[2,3,0,1] row_mask:0xf bank_mask:0xf
    v_mov_b32 v19, v18
    v_max3_u32 v20, v20, v132, v133
    v_max3_u32 v20, v20, v134, v135
    v_permlane16_swap_b32 v18, v19
    v_max_f32 v18, v18, v19
    v_mov_b32 v19, v18
    v_max3_u32 v20, v20, v136, v137
    v_max3_u32 v20, v20, v138, v139
    v_permlane32_swap_b32 v18, v19
    v_max_f32 v18, v18, v19
    v_sub_f32 v22, v21, v18
    v_max3_u32 v20, v20, v140, v141
    v_exp_f32 v22, v22
    v_max3_u32 v20, v20, v142, v143
    v_cmp_eq_u32 vcc, -1, v20
    s_cbranch_vccz ok_42
    s_cmp_lg_u32 s20, 24
    s_cbranch_scc1 lz_46
    buffer_store_dwordx2 v[166:167], v164, s[8:11], s34 offen sc1
    s_mov_b64 exec, s[100:101]
    buffer_store_dword v168, v165, s[8:11], s35 offen sc1
    s_mov_b64 exec, -1
lz_46:
    s_add_u32 s20, s20, 1
    s_cmp_lt_u32 s20, 30000
    s_cbranch_scc1 hv_41
ok_42:
    v_cvt_pk_bf16_f32 v20, v22, v22
    s_nop 1
    v_and_b32_dpp v144, v20, v172 row_newbcast:0 row_mask:0xf bank_mask:0xf
    v_and_b32_dpp v145, v20, v173 row_newbcast:0 row_mask:0xf bank_mask:0xf
    v_and_b32_dpp v146, v20, v174 row_newbcast:0 row_mask:0xf bank_mask:0xf
    v_and_b32_dpp v147, v20, v175 row_newbcast:0 row_mask:0xf bank_mask:0xf
    v_and_b32_dpp v148, v20, v172 row_newbcast:1 row_mask:0xf bank_mask:0xf
    v_and_b32_dpp v149, v20, v173 row_newbcast:1 row_mask:0xf bank_mask:0xf
    v_and_b32_dpp v150, v20, v174 row_newbcast:1 row_mask:0xf bank_mask:0xf
    v_and_b32_dpp v151, v20, v175 row_newbcast:1 row_mask:0xf bank_mask:0xf
    v_mfma_f32_16x16x32_bf16 v[32:35], v[144:147], v[128:131], 0
    v_and_b32_dpp v152, v20, v172 row_newbcast:2 row_mask:0xf bank_mask:0xf
    v_and_b32_dpp v153, v20, v173 row_newbcast:2 row_mask:0xf bank_mask:0xf
    v_and_b32_dpp v154, v20, v174 row_newbcast:2 row_mask:0xf bank_mask:0xf
    v_and_b32_dpp v155, v20, v175 row_newbcast:2 row_mask:0xf bank_mask:0xf
    v_mfma_f32_16x16x32_bf16 v[32:35], v[148:151], v[132:135], v[32:35]
    v_and_b32_dpp v156, v20, v172 row_newbcast:3 row_mask:0xf bank_mask:0xf
    v_and_b32_dpp v157, v20, v173 row_newbcast:3 row_mask:0xf bank_mask:0xf
    v_and_b32_dpp v158, v20, v174 row_newbcast:3 row_mask:0xf bank_mask:0xf
    v_and_b32_dpp v159, v20, v175 row_newbcast:3 row_mask:0xf bank_mask:0xf
    v_mfma_f32_16x16x32_bf16 v[32:35], v[152:155], v[136:139], v[32:35]
    v_and_b32 v22, 0xffff0000, v20
    v_mfma_f32_16x16x32_bf16 v[32:35], v[156:159], v[140:143], v[32:35]
    s_nop 0
    v_add_f32_dpp v22, v22, v22 quad_perm:[1,0,3,2] row_mask:0xf bank_mask:0xf
    s_nop 1
    v_add_f32_dpp v22, v22, v22 quad_perm:[2,3,0,1] row_mask:0xf bank_mask:0xf
    v_mov_b32 v19, v22
    s_nop 1
    v_permlane16_swap_b32 v22, v19
    v_add_f32 v22, v22, v19
    v_mov_b32 v19, v22
    s_nop 1
    v_permlane32_swap_b32 v22, v19
    v_add_f32 v22, v22, v19
    v_rcp_f32 v19, v22
    v_log_f32 v22, v22
    v_mul_f32 v32, v32, v19
    v_mul_f32 v33, v33, v19
    v_mul_f32 v34, v34, v19
    v_mul_f32 v35, v35, v19
    v_add_f32 v22, v22, v18
    v_cvt_pk_bf16_f32 v18, v32, v33
    v_cvt_pk_bf16_f32 v19, v34, v35
    s_mov_b32 exec_hi, 0
    buffer_store_dwordx2 v[18:19], v11, s[8:11], s30 offen sc1
    s_mov_b64 exec, 1
    buffer_store_dword v22, v23, s[8:11], s31 offen sc1
    s_mov_b64 exec, -1
    buffer_store_dwordx2 v[166:167], v164, s[8:11], s34 offen sc1
    s_mov_b64 exec, s[100:101]
    buffer_store_dword v168, v165, s[8:11], s35 offen sc1
    s_mov_b64 exec, -1
    s_cmp_lg_u32 s33, 56
    s_cbranch_scc1 L_fin
    s_lshl_b32 s25, s4, 8
    v_add_u32 v16, s25, v11
    global_load_dwordx2 v[14:15], v16, s[64:65]
    v_lshlrev_b32 v160, 5, v0
    global_load_dwordx4 v[128:131], v160, s[64:65]
    global_load_dwordx4 v[132:135], v160, s[64:65] offset:16
    s_mov_b32 s12, s84
    s_mov_b32 s13, s85
    s_mov_b32 s14, 2048
    s_mov_b32 s15, 0x20000
    buffer_load_dword v175, v16, s[12:15], 0 offen
    v_lshlrev_b32 v17, 1, v11
    s_add_u32 s28, s24, 16384
    s_add_u32 s29, s28, 81920
    s_add_u32 s30, s24, 0
    s_add_u32 s31, s24, 8192
    s_mov_b32 s20, 0
    buffer_load_dwordx4 v[64:67], v12, s[8:11], s30 offen sc1
    buffer_load_dwordx4 v[68:71], v12, s[8:11], s30 offen offset:1024 sc1
    buffer_load_dwordx4 v[72:75], v12, s[8:11], s30 offen offset:2048 sc1
    buffer_load_dwordx4 v[76:79], v12, s[8:11], s30 offen offset:3072 sc1
    buffer_load_dwordx4 v[80:83], v12, s[8:11], s31 offen sc1
    buffer_load_dwordx4 v[84:87], v12, s[8:11], s31 offen offset:1024 sc1
    buffer_load_dwordx4 v[88:91], v12, s[8:11], s31 offen offset:2048 sc1
    buffer_load_dwordx4 v[92:95], v12, s[8:11], s31 offen offset:3072 sc1
    s_waitcnt vmcnt(8)
    v_mov_b32 v165, 0x3f803f80
    v_mov_b32 v164, 0
    v_dot2_f32_bf16 v164, v128, v165, v164
    v_dot2_f32_bf16 v164, v129, v165, v164
    v_dot2_f32_bf16 v164, v130, v165, v164
    v_dot2_f32_bf16 v164, v131, v165, v164
    v_dot2_f32_bf16 v164, v132, v165, v164
    v_dot2_f32_bf16 v164, v133, v165, v164
    v_dot2_f32_bf16 v164, v134, v165, v164
    v_dot2_f32_bf16 v164, v135, v165, v164
    s_nop 2
    v_add_f32_dpp v164, v164, v164 quad_perm:[1,0,3,2] row_mask:0xf bank_mask:0xf
    s_nop 1
    v_add_f32_dpp v164, v164, v164 quad_perm:[2,3,0,1] row_mask:0xf bank_mask:0xf
    s_nop 1
    v_add_f32_dpp v164, v164, v164 row_half_mirror row_mask:0xf bank_mask:0xf
    s_nop 1
    v_add_f32_dpp v164, v164, v164 row_mirror row_mask:0xf bank_mask:0xf
    v_mov_b32 v165, v164
    s_nop 1
    v_permlane16_swap_b32 v164, v165
    v_add_f32 v164, v164, v165
    v_mov_b32 v165, v164
    s_nop 1
    v_permlane32_swap_b32 v164, v165
    v_add_f32 v164, v164, v165
    v_mul_f32 v164, 0x3a800000, v164
    s_branch w_51
hv_47:
    s_and_b32 s21, s20, 63
    s_cmp_eq_u32 s21, 63
    s_cselect_b32 s21, 81920, 0
    s_add_u32 s21, s21, s30
    buffer_load_dwordx4 v[64:67], v12, s[8:11], s21 offen sc1
    buffer_load_dwordx4 v[68:71], v12, s[8:11], s21 offen offset:1024 sc1
    buffer_load_dwordx4 v[72:75], v12, s[8:11], s21 offen offset:2048 sc1
    buffer_load_dwordx4 v[76:79], v12, s[8:11], s21 offen offset:3072 sc1
    s_sub_u32 s38, s21, s30
    s_add_u32 s38, s38, s31
    buffer_load_dwordx4 v[80:83], v12, s[8:11], s38 offen sc1
    buffer_load_dwordx4 v[84:87], v12, s[8:11], s38 offen offset:1024 sc1
    buffer_load_dwordx4 v[88:91], v12, s[8:11], s38 offen offset:2048 sc1
    buffer_load_dwordx4 v[92:95], v12, s[8:11], s38 offen offset:3072 sc1
w_51:
    s_waitcnt vmcnt(0)
    v_mfma_f32_16x16x32_bf16 v[32:35], v[24:27], v[64:67], 0
    v_mfma_f32_16x16x32_bf16 v[40:43], v[24:27], v[80:83], 0
    v_mfma_f32_16x16x32_bf16 v[32:35], v[24:27], v[68:71], v[32:35]
    v_mfma_f32_16x16x32_bf16 v[40:43], v[24:27], v[84:87], v[40:43]
    v_mfma_f32_16x16x32_bf16 v[32:35], v[24:27], v[72:75], v[32:35]
    v_mfma_f32_16x16x32_bf16 v[40:43], v[24:27], v[88:91], v[40:43]
    v_mfma_f32_16x16x32_bf16 v[32:35], v[24:27], v[76:79], v[32:35]
    v_mfma_f32_16x16x32_bf16 v[40:43], v[24:27], v[92:95], v[40:43]
    v_lshlrev_b32 v48, 16, v14
    v_and_b32 v49, 0xffff0000, v14
    v_lshlrev_b32 v50, 16, v15
    v_and_b32 v51, 0xffff0000, v15
    v_sub_f32 v48, v48, v164
    v_sub_f32 v49, v49, v164
    v_sub_f32 v50, v50, v164
    v_sub_f32 v51, v51, v164
    v_add_f32 v40, 1.0, v40
    v_add_f32 v41, 1.0, v41
    v_add_f32 v42, 1.0, v42
    v_add_f32 v43, 1.0, v43
    v_mul_f32 v52, v32, v40
    v_mul_f32 v53, v33, v41
    v_mul_f32 v54, v34, v42
    v_mul_f32 v55, v35, v43
    v_cmp_u_f32 vcc, v52, v52
    s_cbranch_vccz ok_48
    s_add_u32 s20, s20, 1
    s_cmp_ge_u32 s20, 30000
    s_cbranch_scc1 ok_48
    v_cmp_ne_u32 vcc, -1, v64
    s_cbranch_vccnz hv_47
lt_49:
    s_sleep 1
lt2_50:
    s_and_b32 s21, s20, 63
    s_cmp_eq_u32 s21, 63
    s_cselect_b32 s21, 81920, 0
    s_add_u32 s21, s21, s30
    buffer_load_dwordx4 v[64:67], v12, s[8:11], s21 offen sc1
    s_waitcnt vmcnt(0)
    v_cmp_ne_u32 vcc, -1, v64
    s_cbranch_vccnz hv_47
    s_add_u32 s20, s20, 1
    s_cmp_lt_u32 s20, 30000
    s_cbranch_scc1 lt_49
ok_48:
    v_mul_f32 v56, v48, v40
    v_mul_f32 v57, v49, v41
    v_mul_f32 v58, v50, v42
    v_mul_f32 v59, v51, v43
    v_cvt_pk_bf16_f32 v18, v40, v41
    v_cvt_pk_bf16_f32 v19, v42, v43
    s_mov_b32 exec_hi, 0
    buffer_store_dwordx4 v[52:55], v17, s[8:11], s28 offen
    buffer_store_dwordx4 v[56:59], v17, s[8:11], s28 offen offset:512
    buffer_store_dwordx2 v[18:19], v11, s[8:11], s28 offen offset:1024
    buffer_store_dwordx4 v[52:55], v17, s[8:11], s29 offen sc1
    buffer_store_dwordx4 v[56:59], v17, s[8:11], s29 offen offset:512 sc1
    buffer_store_dwordx2 v[18:19], v11, s[8:11], s29 offen offset:1024 sc1
    s_mov_b64 exec, -1
    s_add_u32 s28, s24, 20480
    s_lshl_b32 s29, s4, 7
    s_add_u32 s29, s29, 458752
    s_mov_b32 s20, 0
hv_52:
    s_and_b32 s21, s20, 63
    s_cmp_eq_u32 s21, 63
    s_cselect_b32 s21, 81920, 0
    s_add_u32 s21, s21, s28
    buffer_load_dwordx4 v[128:131], v12, s[8:11], s21 offen sc1
    buffer_load_dwordx4 v[132:135], v12, s[8:11], s21 offen offset:1024 sc1
    buffer_load_dwordx4 v[136:139], v12, s[8:11], s21 offen offset:2048 sc1
    buffer_load_dwordx4 v[140:143], v12, s[8:11], s21 offen offset:3072 sc1
    s_add_u32 s22, s21, 4096
    buffer_load_dwordx4 v[144:147], v12, s[8:11], s22 offen sc1
    buffer_load_dwordx4 v[148:151], v12, s[8:11], s22 offen offset:1024 sc1
    buffer_load_dwordx4 v[152:155], v12, s[8:11], s22 offen offset:2048 sc1
    buffer_load_dwordx4 v[156:159], v12, s[8:11], s22 offen offset:3072 sc1
w_56:
    s_waitcnt vmcnt(0)
    v_mfma_f32_16x16x32_bf16 v[36:39], v[24:27], v[128:131], 0
    v_mfma_f32_16x16x32_bf16 v[36:39], v[24:27], v[132:135], v[36:39]
    v_mfma_f32_16x16x32_bf16 v[36:39], v[24:27], v[136:139], v[36:39]
    v_mfma_f32_16x16x32_bf16 v[36:39], v[24:27], v[140:143], v[36:39]
    v_mfma_f32_16x16x32_bf16 v[36:39], v[24:27], v[144:147], v[36:39]
    v_mfma_f32_16x16x32_bf16 v[36:39], v[24:27], v[148:151], v[36:39]
    v_mfma_f32_16x16x32_bf16 v[36:39], v[24:27], v[152:155], v[36:39]
    v_mfma_f32_16x16x32_bf16 v[36:39], v[24:27], v[156:159], v[36:39]
    s_nop 7
    v_fma_f32 v60, v32, v36, v48
    v_fma_f32 v61, v33, v37, v49
    v_fma_f32 v62, v34, v38, v50
    v_fma_f32 v63, v35, v39, v51
    v_cmp_u_f32 vcc, v36, v36
    s_cbranch_vccz ok_53
    s_add_u32 s20, s20, 1
    s_cmp_ge_u32 s20, 30000
    s_cbranch_scc1 ok_53
    v_cmp_ne_u32 vcc, -1, v128
    s_cbranch_vccnz hv_52
lt_54:
    s_sleep 1
lt2_55:
    s_and_b32 s21, s20, 63
    s_cmp_eq_u32 s21, 63
    s_cselect_b32 s21, 81920, 0
    s_add_u32 s21, s21, s28
    buffer_load_dwordx4 v[128:131], v12, s[8:11], s21 offen sc1
    s_waitcnt vmcnt(0)
    v_cmp_ne_u32 vcc, -1, v128
    s_cbranch_vccnz hv_52
    s_add_u32 s20, s20, 1
    s_cmp_lt_u32 s20, 30000
    s_cbranch_scc1 lt_54
ok_53:
    v_add_f32 v160, v60, v61
    v_mul_f32 v161, v60, v60
    v_add_f32 v162, v62, v63
    v_fmac_f32 v161, v61, v61
    v_fmac_f32 v161, v62, v62
    v_fmac_f32 v161, v63, v63
    v_add_f32 v160, v160, v162
    s_nop 1
    v_add_f32_dpp v160, v160, v160 quad_perm:[1,0,3,2] row_mask:0xf bank_mask:0xf
    v_add_f32_dpp v161, v161, v161 quad_perm:[1,0,3,2] row_mask:0xf bank_mask:0xf
    s_nop 0
    v_add_f32_dpp v160, v160, v160 quad_perm:[2,3,0,1] row_mask:0xf bank_mask:0xf
    v_add_f32_dpp v161, v161, v161 quad_perm:[2,3,0,1] row_mask:0xf bank_mask:0xf
    s_nop 0
    v_add_f32_dpp v160, v160, v160 row_half_mirror row_mask:0xf bank_mask:0xf
    v_add_f32_dpp v161, v161, v161 row_half_mirror row_mask:0xf bank_mask:0xf
    s_nop 0
    v_add_f32_dpp v160, v160, v160 row_mirror row_mask:0xf bank_mask:0xf
    v_add_f32_dpp v161, v161, v161 row_mirror row_mask:0xf bank_mask:0xf
    v_mov_b32 v162, v160
    v_mov_b32 v163, v161
    s_nop 0
    v_permlane16_swap_b32 v160, v162
    v_permlane16_swap_b32 v161, v163
    v_add_f32 v160, v160, v162
    v_add_f32 v161, v161, v163
    s_mov_b64 exec, 1
    buffer_store_dwordx2 v[160:161], v23, s[8:11], s29 offen sc1
    s_mov_b64 exec, -1
    v_add_f32 v60, v60, v164
    v_add_f32 v61, v61, v164
    v_add_f32 v62, v62, v164
    v_add_f32 v63, v63, v164
    s_add_u32 s28, s24, 28672
    s_add_u32 s30, s24, 12288
    s_mov_b32 s20, 0
hv_57:
    s_and_b32 s21, s20, 63
    s_cmp_eq_u32 s21, 63
    s_cselect_b32 s21, 81920, 0
    s_add_u32 s21, s21, s30
    buffer_load_dwordx4 v[64:67], v12, s[8:11], s21 offen sc1
    buffer_load_dwordx4 v[68:71], v12, s[8:11], s21 offen offset:1024 sc1
    buffer_load_dwordx4 v[72:75], v12, s[8:11], s21 offen offset:2048 sc1
    buffer_load_dwordx4 v[76:79], v12, s[8:11], s21 offen offset:3072 sc1
w_61:
    s_waitcnt vmcnt(0)
    v_mfma_f32_16x16x32_bf16 v[44:47], v[24:27], v[64:67], 0
    v_mfma_f32_16x16x32_bf16 v[44:47], v[24:27], v[68:71], v[44:47]
    v_mfma_f32_16x16x32_bf16 v[44:47], v[24:27], v[72:75], v[44:47]
    v_mfma_f32_16x16x32_bf16 v[44:47], v[24:27], v[76:79], v[44:47]
    s_nop 7
    v_cmp_u_f32 vcc, v44, v44
    s_cbranch_vccz ok_58
    s_add_u32 s20, s20, 1
    s_cmp_ge_u32 s20, 30000
    s_cbranch_scc1 ok_58
    v_cmp_ne_u32 vcc, -1, v64
    s_cbranch_vccnz hv_57
lt_59:
    s_sleep 1
lt2_60:
    s_and_b32 s21, s20, 63
    s_cmp_eq_u32 s21, 63
    s_cselect_b32 s21, 81920, 0
    s_add_u32 s21, s21, s30
    buffer_load_dwordx4 v[64:67], v12, s[8:11], s21 offen sc1
    s_waitcnt vmcnt(0)
    v_cmp_ne_u32 vcc, -1, v64
    s_cbranch_vccnz hv_57
    s_add_u32 s20, s20, 1
    s_cmp_lt_u32 s20, 30000
    s_cbranch_scc1 lt_59
ok_58:
    s_mov_b32 s20, 0
hv_62:
    s_and_b32 s21, s20, 63
    s_cmp_eq_u32 s21, 63
    s_cselect_b32 s21, 81920, 0
    s_add_u32 s21, s21, s28
    buffer_load_dwordx4 v[128:131], v12, s[8:11], s21 offen sc1
    buffer_load_dwordx4 v[132:135], v12, s[8:11], s21 offen offset:1024 sc1
    buffer_load_dwordx4 v[136:139], v12, s[8:11], s21 offen offset:2048 sc1
    buffer_load_dwordx4 v[140:143], v12, s[8:11], s21 offen offset:3072 sc1
    s_add_u32 s22, s21, 4096
    buffer_load_dwordx4 v[144:147], v12, s[8:11], s22 offen sc1
    buffer_load_dwordx4 v[148:151], v12, s[8:11], s22 offen offset:1024 sc1
    buffer_load_dwordx4 v[152:155], v12, s[8:11], s22 offen offset:2048 sc1
w_66:
    s_waitcnt vmcnt(0)
    v_mfma_f32_16x16x32_bf16 v[36:39], v[24:27], v[128:131], 0
    v_mfma_f32_16x16x32_bf16 v[36:39], v[24:27], v[132:135], v[36:39]
    v_mfma_f32_16x16x32_bf16 v[36:39], v[24:27], v[136:139], v[36:39]
    v_mfma_f32_16x16x32_bf16 v[36:39], v[24:27], v[140:143], v[36:39]
    v_mfma_f32_16x16x32_bf16 v[36:39], v[24:27], v[144:147], v[36:39]
    v_mfma_f32_16x16x32_bf16 v[36:39], v[24:27], v[148:151], v[36:39]
    v_mfma_f32_16x16x32_bf16 v[36:39], v[24:27], v[152:155], v[36:39]
    s_nop 7
    v_fma_f32 v40, v44, v36, v60
    v_fma_f32 v41, v45, v37, v61
    v_fma_f32 v42, v46, v38, v62
    v_fma_f32 v43, v47, v39, v63
    v_cvt_pk_bf16_f32 v18, v40, v41
    v_cvt_pk_bf16_f32 v19, v42, v43
    v_cmp_u_f32 vcc, v36, v36
    s_cbranch_vccz ok_63
    s_add_u32 s20, s20, 1
    s_cmp_ge_u32 s20, 30000
    s_cbranch_scc1 ok_63
    v_cmp_ne_u32 vcc, -1, v128
    s_cbranch_vccnz hv_62
lt_64:
    s_sleep 1
lt2_65:
    s_and_b32 s21, s20, 63
    s_cmp_eq_u32 s21, 63
    s_cselect_b32 s21, 81920, 0
    s_add_u32 s21, s21, s28
    buffer_load_dwordx4 v[128:131], v12, s[8:11], s21 offen sc1
    s_waitcnt vmcnt(0)
    v_cmp_ne_u32 vcc, -1, v128
    s_cbranch_vccnz hv_62
    s_add_u32 s20, s20, 1
    s_cmp_lt_u32 s20, 30000
    s_cbranch_scc1 lt_64
ok_63:
    s_mov_b32 exec_hi, 0
    buffer_store_dwordx2 v[18:19], v16, s[12:15], 0 offen
    s_cmp_lg_u32 s4, 0
    s_cbranch_scc1 L_Fdone
    s_mov_b64 exec, 1
    v_mov_b32 v20, s7
    buffer_store_dword v20, v23, s[8:11], 0 offen offset:0
L_Fdone:
    s_mov_b64 exec, -1
L_fin:
L_end:
L_last:
    s_endpgm
.section .rodata,"a"
.p2align 6
.amdhsa_kernel adaLN_cond__sliding_block_cached__dense_activation_silu__decode_kernel
  .amdhsa_next_free_vgpr 208
  .amdhsa_next_free_sgpr 102
  .amdhsa_accum_offset 208
  .amdhsa_group_segment_fixed_size 0
  .amdhsa_kernarg_size 104
  .amdhsa_user_sgpr_count 2
  .amdhsa_user_sgpr_kernarg_segment_ptr 1
  .amdhsa_system_sgpr_workgroup_id_x 1
.end_amdhsa_kernel
```
